```python
import torch

def _softmax(x, axis=-1):
    return torch.softmax(x, dim=axis)
def _gelu(x):
    return torch.nn.functional.gelu(x, approximate="tanh")
def _silu(x):
    return torch.nn.functional.silu(x)
def _sigmoid(x):
    return torch.sigmoid(x)
def _layernorm(x, axis=-1, eps=1e-5):
    m = x.mean(dim=axis, keepdim=True)
    v = x.var(dim=axis, keepdim=True, unbiased=False)
    return (x - m) / torch.sqrt(v + eps)
def _scatter_add(tgt, idx, src, axis=0):
    return tgt.clone().index_add_(axis, idx, src)
def _segment_sum(src, seg, n):
    out = torch.zeros((n,) + src.shape[1:], dtype=src.dtype)
    return out.index_add_(0, seg, src)
def _pad(x, pw):
    flat = tuple(v for pair in reversed(pw) for v in pair)
    return torch.nn.functional.pad(x, flat)

kernel_name = 'gated_mix__ssm_conv_s4__dense_activation_relu__prompt'

def setup_inputs():

    _w = (lambda a: (lambda t: t.to(torch.bfloat16) if t.is_floating_point() else t)(torch.as_tensor(a)))
    def _A_setup():
        B, L, D, N = 1, 2048, 512, 128
        A_re = -(lambda _x: torch.exp(torch.as_tensor(_x)))((lambda *s: torch.randn(*s, dtype=torch.bfloat16) * 3.2)(D, N))
        A_im = torch.pi * (lambda *s: torch.randn(*s, dtype=torch.bfloat16) * 0.2)(D, N)
        B_re = (lambda *s: torch.randn(*s, dtype=torch.bfloat16) * 0.4)(D, N)
        B_im = (lambda *s: torch.randn(*s, dtype=torch.bfloat16) * 0.4)(D, N)
        C_re = (lambda *s: torch.randn(*s, dtype=torch.bfloat16) * 0.4)(D, N)
        C_im = (lambda *s: torch.randn(*s, dtype=torch.bfloat16) * 0.4)(D, N)
        log_dt = (lambda *s: torch.randn(*s, dtype=torch.bfloat16) * 0.2)(D) * 0.5 - 4.0
        Dskip = (lambda *s: torch.randn(*s, dtype=torch.bfloat16) * 0.4)(D)
        return {
            "u": _w((lambda *s: torch.randn(*s, dtype=torch.bfloat16) * 0.05)(B, L, D)),
            "A_re": _w(A_re),
            "A_im": _w(A_im),
            "B_re": _w(B_re),
            "B_im": _w(B_im),
            "C_re": _w(C_re),
            "C_im": _w(C_im),
            "log_dt": _w(log_dt),
            "Dskip": _w(Dskip),
        }
    _A_in = _A_setup()

    def _B_setup():
        B, S, D, Dff = 1, 2048, 512, 1792
        return {
            "x": _w((lambda *s: torch.randn(*s, dtype=torch.bfloat16) * 0.05)(B, S, D)),
            "w1": _w((lambda *s: torch.randn(*s, dtype=torch.bfloat16) * 0.05)(D, Dff)),
            "w2": _w((lambda *s: torch.randn(*s, dtype=torch.bfloat16) * 0.05)(Dff, D)),
        }
    _B_in = _B_setup()

    return {
        "A_u": _A_in["u"],
        "A_A_re": _A_in["A_re"],
        "A_A_im": _A_in["A_im"],
        "A_B_re": _A_in["B_re"],
        "A_B_im": _A_in["B_im"],
        "A_C_re": _A_in["C_re"],
        "A_C_im": _A_in["C_im"],
        "A_log_dt": _A_in["log_dt"],
        "A_Dskip": _A_in["Dskip"],
        "B_x": _B_in["x"],
        "B_w1": _B_in["w1"],
        "B_w2": _B_in["w2"],
        "gate_w": _w((lambda *s: torch.randn(*s, dtype=torch.bfloat16) * 0.05)(512) * 16.0),
    }

def reference(A_u, A_A_re, A_A_im, A_B_re, A_B_im, A_C_re, A_C_im, A_log_dt, A_Dskip, B_x, B_w1, B_w2, gate_w):
    def _A_ref(u, A_re, A_im, B_re, B_im, C_re, C_im, log_dt, Dskip):
        Bsz, L, D = u.shape
        dt = torch.exp(log_dt)[:, None]
        A = A_re + 1j * A_im
        Bc = B_re + 1j * B_im
        Cc = C_re + 1j * C_im
        logdA = dt * A
        dB = dt * Bc
        l = (lambda x, dt: x.to(dt))(torch.arange(L), A_re.dtype)
        P = torch.exp(logdA[:, :, None] * l[None, None, :])
        K = torch.einsum("dn,dnl,dn->dl", Cc, P, dB).real
        L2 = 2 * L
        Kp = _pad(K, ((0, 0), (0, L)))
        up = (lambda x, *d: x.permute(*d))(u, 0, 2, 1)
        up = _pad(up, ((0, 0), (0, 0), (0, L)))
        Kf = (lambda x, axes=(-2,-1): torch.fft.rfft2(x.float(), dim=axes))(Kp[:, None, :], axes=(-2, -1))
        Uf = (lambda x, axes=(-2,-1): torch.fft.rfft2(x.float(), dim=axes))(up[:, :, None, :], axes=(-2, -1))
        Yf = Uf * Kf[None, :, :, :]
        y = (lambda x, s, axes=(-2,-1): torch.fft.irfft2(x, s=s, dim=axes).to(torch.bfloat16))(Yf, (1, L2), axes=(-2, -1))[:, :, 0, :L]
        y = (lambda x, *d: x.permute(*d))(y, 0, 2, 1) + u * Dskip[None, None, :]
        return y

    def _B_ref(x, w1, w2):
        h = torch.einsum("bsd,df->bsf", x, w1)
        zero = torch.zeros_like(h)
        h = torch.maximum(h, zero)
        return torch.einsum("bsf,fd->bsd", h, w2)

    x = A_u
    g = _sigmoid((x * gate_w).sum(-1, keepdims=True))
    a = _A_ref(x, A_A_re, A_A_im, A_B_re, A_B_im, A_C_re, A_C_im, A_log_dt, A_Dskip)
    b = _B_ref(x, B_w1, B_w2)
    return g * a + (1 - g) * b
```

```asm
; @launch grid=(256,1,1) block=(512,1,1) lds=163840
.amdgcn_target "amdgcn-amd-amdhsa--gfx950"
.text
.globl gated_mix__ssm_conv_s4__dense_activation_relu__prompt_kernel
.p2align 8
.type gated_mix__ssm_conv_s4__dense_activation_relu__prompt_kernel,@function
gated_mix__ssm_conv_s4__dense_activation_relu__prompt_kernel:
    s_cmp_ge_u32 s2, 256
    s_cbranch_scc1 L_end
    s_lshr_b32 s5, s2, 3
    s_min_u32 s3, s5, 15
    s_lshl_b32 s3, s3, 3
    s_load_dwordx2 s[68:69], s[0:1], s3
    s_load_dwordx16 s[16:31], s[0:1], 0
    s_load_dwordx16 s[32:47], s[0:1], 64
    s_getpc_b64 s[8:9]
L_pc:
    s_lshl_b32 s3, s5, 10
    v_lshl_add_u32 v6, v0, 2, s3
    v_min_u32 v6, L_end-L_pc, v6
    v_readfirstlane_b32 s14, v0
    v_and_b32 v1, 63, v0
    v_bfe_u32 v4, v0, 6, 2
    s_and_b32 s4, s2, 7
    s_mul_i32 s77, s5, 37
    s_lshr_b32 s77, s77, 8
    s_bfe_u32 s6, s14, 0x20006
    s_mul_i32 s13, s77, 7
    s_sub_u32 s15, s5, s13
    s_and_b32 s11, s4, 6
    s_lshl1_add_u32 s11, s11, s77
    s_lshl_b32 s70, s11, 17
    s_and_b32 s11, s4, 1
    s_mul_i32 s11, s11, 7
    s_add_u32 s11, s11, s15
    s_lshl_b32 s71, s11, 8
    s_add_u32 s72, s77, s15
    s_lshl_b32 s72, s72, 2
    s_lshl_b32 s73, s6, 12
    s_mov_b32 s50, 2097152
    s_mov_b32 s51, 0x00020000
    s_mov_b32 s54, 1835008
    s_mov_b32 s55, s51
    s_bitcmp1_b32 s14, 8
    s_cbranch_scc1 L_roleB0
    global_load_dword v6, v6, s[8:9]
    s_max_u32 s3, s5, 15
    s_min_u32 s3, s3, 20
    s_sub_u32 s3, s3, 15
    v_lshlrev_b32 v12, 21, s3
    v_lshrrev_b32 v8, 3, v1
    v_lshl_add_u32 v8, v4, 5, v8
    v_lshlrev_b32 v8, 10, v8
    v_lshrrev_b32 v9, 4, v1
    v_and_b32 v10, 7, v1
    v_xor_b32 v10, v10, v9
    v_lshl_add_u32 v16, v10, 4, v8
    v_xor_b32 v10, 4, v10
    v_lshl_add_u32 v17, v10, 4, v8
    v_add_u32 v17, 7168, v17
    v_add_u32 v18, 14336, v16
    v_add_u32 v19, 14336, v17
    v_lshl_add_u32 v8, v4, 4, v9
    v_mul_u32_u24 v8, 3584, v8
    v_and_b32 v10, 15, v1
    v_lshlrev_b32 v11, 2, v9
    v_xor_b32 v10, v10, v11
    v_lshl_add_u32 v20, v10, 4, v8
    v_add_u32 v21, 13312, v20
    v_xor_b32 v10, 2, v10
    v_lshl_add_u32 v8, v10, 4, v8
    v_add_u32 v22, 26624, v8
    v_add_u32 v23, 39936, v8
    s_add_u32 s74, s72, 0
    s_and_b32 s74, s74, 7
    s_mul_i32 s75, s74, 229376
    s_add_u32 s75, s75, s71
    s_lshl_b32 s74, s74, 7
    s_add_u32 s74, s74, s70
    s_waitcnt lgkmcnt(0)
    global_load_dword v6, v12, s[68:69] offset:128
    s_mov_b64 s[48:49], s[16:17]
    s_mov_b64 s[52:53], s[36:37]
    s_cmp_ge_u32 s5, 28
    s_cbranch_scc1 L_spare
    s_add_u32 m0, s73, 98304
    s_nop 0
    buffer_load_dwordx4 v16, s[48:51], s74 offen offset:0 lds
    s_barrier
    buffer_load_dwordx4 v17, s[48:51], s74 offen offset:1024 lds
    buffer_load_dwordx4 v18, s[48:51], s74 offen offset:2048 lds
    buffer_load_dwordx4 v19, s[48:51], s74 offen offset:3072 lds
    s_add_u32 m0, s73, 114688
    s_nop 0
    buffer_load_dwordx4 v20, s[52:55], s75 offen offset:0 lds
    buffer_load_dwordx4 v21, s[52:55], s75 offen offset:1024 lds
    buffer_load_dwordx4 v22, s[52:55], s75 offen offset:2048 lds
    buffer_load_dwordx4 v23, s[52:55], s75 offen offset:3072 lds
    s_add_u32 s74, s72, 1
    s_and_b32 s74, s74, 7
    s_mul_i32 s75, s74, 229376
    s_add_u32 s75, s75, s71
    s_lshl_b32 s74, s74, 7
    s_add_u32 s74, s74, s70
    s_add_u32 m0, s73, 131072
    s_nop 0
    buffer_load_dwordx4 v16, s[48:51], s74 offen offset:0 lds
    buffer_load_dwordx4 v17, s[48:51], s74 offen offset:1024 lds
    buffer_load_dwordx4 v18, s[48:51], s74 offen offset:2048 lds
    s_setprio 2
    v_mov_b32 v3, 0
    v_lshlrev_b32 v7, 4, v1
    s_mov_b32 s66, 12582912
    s_mov_b32 s67, 0x00020000
    s_mov_b64 s[64:65], s[46:47]
    s_lshl_b32 s76, s6, 11
    s_add_u32 s76, s76, 65536
    s_mov_b32 s58, 1835008
    s_mov_b32 s59, 0x00020000
    s_mov_b32 s62, 2097152
    s_mov_b32 s63, 0x00020000
    s_mov_b64 s[56:57], s[38:39]
    s_mov_b64 s[60:61], s[42:43]
    s_load_dword s16, s[46:47], 128
    v_and_b32 v8, 15, v1
    v_lshrrev_b32 v9, 4, v1
    v_lshrrev_b32 v10, 1, v8
    v_xor_b32 v10, v10, v9
    s_lshr_b32 s8, s6, 1
    s_lshl_b32 s8, s8, 13
    s_add_u32 s8, s8, 81920
    v_lshl_add_u32 v8, v8, 7, s8
    v_lshl_add_u32 v4, v10, 4, v8
    v_xor_b32 v5, 64, v4
    v_bfe_u32 v8, v1, 2, 2
    v_lshl_add_u32 v10, v9, 3, v8
    v_lshlrev_b32 v10, 8, v10
    v_and_b32 v9, 1, v9
    v_lshl_or_b32 v8, v8, 1, v9
    s_and_b32 s8, s6, 1
    s_lshl_b32 s8, s8, 2
    v_xor_b32 v8, s8, v8
    v_lshl_add_u32 v10, v8, 5, v10
    v_and_b32 v8, 3, v1
    v_lshl_add_u32 v10, v8, 3, v10
    v_add_u32 v24, 114688, v10
    v_xor_b32 v25, 32, v24
    v_xor_b32 v26, 64, v24
    v_xor_b32 v27, 96, v24
    v_add_u32 v28, 65536, v10
    v_xor_b32 v29, 32, v28
    v_xor_b32 v30, 64, v28
    v_xor_b32 v31, 96, v28
    s_lshl2_add_u32 s8, s4, s77
    s_lshr_b32 s9, s6, 1
    s_lshl1_add_u32 s8, s8, s9
    s_mul_i32 s8, s8, 112
    s_and_b32 s10, s6, 1
    s_lshl1_add_u32 s10, s15, s10
    s_lshl1_add_u32 s8, s10, s8
    s_lshl_b32 s8, s8, 10
    s_add_u32 s32, s8, 5242880
    s_and_b32 s8, s4, 6
    s_lshl1_add_u32 s8, s8, s77
    s_lshl1_add_u32 s8, s8, s9
    s_and_b32 s9, s4, 1
    s_lshl1_add_u32 s8, s8, s9
    s_lshl_b32 s8, s8, 8
    s_cmp_ge_u32 s10, 7
    s_cselect_b32 s9, 100, 0
    s_lshl2_add_u32 s8, s10, s8
    s_add_u32 s8, s8, s9
    s_add_u32 s34, s8, 262144
    v_lshrrev_b32 v8, 3, v1
    v_lshlrev_b32 v8, 10, v8
    v_lshrrev_b32 v9, 4, v1
    v_lshlrev_b32 v9, 1, v9
    v_and_b32 v10, 7, v1
    v_xor_b32 v10, v10, v9
    v_lshl_add_u32 v10, v10, 4, v8
    v_add_u32 v11, 7168, v10
    s_cmp_ge_u32 s15, 3
    s_addc_u32 s8, s15, 0
    s_cmp_ge_u32 s5, 28
    s_cselect_b32 s31, 3, s8
    s_cselect_b32 s30, s15, s77
    s_mul_i32 s12, s6, 458752
    s_lshl_b32 s10, s31, 7
    s_add_u32 s12, s12, s10
    s_and_b32 s10, s4, 6
    s_lshr_b32 s11, s6, 1
    s_add_u32 s10, s10, s11
    s_and_b32 s11, s4, 1
    s_lshl1_add_u32 s10, s10, s11
    s_lshl2_add_u32 s10, s10, s30
    s_mul_i32 s10, s10, 112
    s_and_b32 s11, s6, 1
    s_mul_i32 s3, s11, 14
    s_add_u32 s10, s10, s3
    s_lshl_b32 s10, s10, 10
    s_add_u32 s13, s10, 5242880
    s_xor_b32 s3, s6, 0
    s_mul_i32 s3, s3, 28672
    v_add_u32 v12, s3, v7
    s_xor_b32 s3, s6, 1
    s_mul_i32 s3, s3, 28672
    v_add_u32 v13, s3, v7
    s_xor_b32 s3, s6, 2
    s_mul_i32 s3, s3, 28672
    v_add_u32 v14, s3, v7
    s_xor_b32 s3, s6, 3
    s_mul_i32 s3, s3, 28672
    v_add_u32 v15, s3, v7
    s_mov_b32 s10, 0
    s_add_u32 s11, s10, 0
    s_and_b32 s11, s11, 1
    s_mul_i32 s3, s11, 229376
    s_add_u32 s36, s12, s3
    s_mul_i32 s3, s11, 7168
    s_add_u32 s40, s13, s3
    s_add_u32 s11, s10, 1
    s_and_b32 s11, s11, 1
    s_mul_i32 s3, s11, 229376
    s_add_u32 s37, s12, s3
    s_mul_i32 s3, s11, 7168
    s_add_u32 s41, s13, s3
    buffer_load_dwordx4 v19, s[48:51], s74 offen offset:3072 lds
    s_add_u32 m0, s73, 147456
    s_nop 0
    buffer_load_dwordx4 v20, s[52:55], s75 offen offset:0 lds
    buffer_load_dwordx4 v21, s[52:55], s75 offen offset:1024 lds
    buffer_load_dwordx4 v22, s[52:55], s75 offen offset:2048 lds
    buffer_load_dwordx4 v23, s[52:55], s75 offen offset:3072 lds
    s_add_u32 s74, s72, 2
    s_and_b32 s74, s74, 7
    s_mul_i32 s75, s74, 229376
    s_add_u32 s75, s75, s71
    s_lshl_b32 s74, s74, 7
    s_add_u32 s74, s74, s70
    s_add_u32 m0, s73, 81920
    s_nop 0
    buffer_load_dwordx4 v16, s[48:51], s74 offen offset:0 lds
    buffer_load_dwordx4 v17, s[48:51], s74 offen offset:1024 lds
    buffer_load_dwordx4 v18, s[48:51], s74 offen offset:2048 lds
    buffer_load_dwordx4 v19, s[48:51], s74 offen offset:3072 lds
    s_add_u32 m0, s73, 65536
    s_nop 0
    buffer_load_dwordx4 v20, s[52:55], s75 offen offset:0 lds
    buffer_load_dwordx4 v21, s[52:55], s75 offen offset:1024 lds
    buffer_load_dwordx4 v22, s[52:55], s75 offen offset:2048 lds
    buffer_load_dwordx4 v23, s[52:55], s75 offen offset:3072 lds
    s_lshl_b32 s8, s2, 13
    s_lshl_b32 s9, s6, 11
    s_add_u32 s8, s8, s9
    buffer_load_dwordx4 v[96:99], v7, s[56:59], s8 offen
    buffer_load_dwordx4 v[100:103], v7, s[56:59], s8 offen offset:1024
    v_mov_b32 v9, 1
    s_waitcnt vmcnt(18)
    s_barrier
    ds_read_b128 v[32:35], v4 offset:16384
    ds_read_b64_tr_b16 v[48:49], v24 offset:0
    ds_read_b64_tr_b16 v[50:51], v24 offset:1024
    ds_read_b128 v[36:39], v4 offset:18432
    ds_read_b64_tr_b16 v[52:53], v25 offset:0
    ds_read_b64_tr_b16 v[54:55], v25 offset:1024
    ds_read_b128 v[40:43], v4 offset:20480
    ds_read_b64_tr_b16 v[56:57], v26 offset:0
    ds_read_b64_tr_b16 v[58:59], v26 offset:1024
    ds_read_b128 v[44:47], v4 offset:22528
    ds_read_b64_tr_b16 v[60:61], v27 offset:0
    ds_read_b64_tr_b16 v[62:63], v27 offset:1024
    s_waitcnt lgkmcnt(0)
    v_mfma_f32_16x16x32_bf16 v[192:195], v[48:51], v[32:35], 0
    ds_read_b128 v[64:67], v5 offset:16384
    v_mfma_f32_16x16x32_bf16 v[196:199], v[52:55], v[32:35], 0
    ds_read_b64_tr_b16 v[80:81], v24 offset:8192
    v_mfma_f32_16x16x32_bf16 v[200:203], v[56:59], v[32:35], 0
    ds_read_b64_tr_b16 v[82:83], v24 offset:9216
    v_mfma_f32_16x16x32_bf16 v[204:207], v[60:63], v[32:35], 0
    ds_read_b128 v[68:71], v5 offset:18432
    v_mfma_f32_16x16x32_bf16 v[208:211], v[48:51], v[36:39], 0
    ds_read_b64_tr_b16 v[84:85], v25 offset:8192
    v_mfma_f32_16x16x32_bf16 v[212:215], v[52:55], v[36:39], 0
    ds_read_b64_tr_b16 v[86:87], v25 offset:9216
    v_mfma_f32_16x16x32_bf16 v[216:219], v[56:59], v[36:39], 0
    ds_read_b128 v[72:75], v5 offset:20480
    v_mfma_f32_16x16x32_bf16 v[220:223], v[60:63], v[36:39], 0
    ds_read_b64_tr_b16 v[88:89], v26 offset:8192
    v_mfma_f32_16x16x32_bf16 v[224:227], v[48:51], v[40:43], 0
    ds_read_b64_tr_b16 v[90:91], v26 offset:9216
    v_mfma_f32_16x16x32_bf16 v[228:231], v[52:55], v[40:43], 0
    ds_read_b128 v[76:79], v5 offset:22528
    v_mfma_f32_16x16x32_bf16 v[232:235], v[56:59], v[40:43], 0
    ds_read_b64_tr_b16 v[92:93], v27 offset:8192
    v_mfma_f32_16x16x32_bf16 v[236:239], v[60:63], v[40:43], 0
    ds_read_b64_tr_b16 v[94:95], v27 offset:9216
    v_mfma_f32_16x16x32_bf16 v[240:243], v[48:51], v[44:47], 0
    v_mfma_f32_16x16x32_bf16 v[244:247], v[52:55], v[44:47], 0
    v_mfma_f32_16x16x32_bf16 v[248:251], v[56:59], v[44:47], 0
    v_mfma_f32_16x16x32_bf16 v[252:255], v[60:63], v[44:47], 0
    s_waitcnt vmcnt(10) lgkmcnt(0)
    s_barrier
    v_mfma_f32_16x16x32_bf16 v[192:195], v[80:83], v[64:67], v[192:195]
    ds_read_b128 v[32:35], v4 offset:49152
    v_mfma_f32_16x16x32_bf16 v[196:199], v[84:87], v[64:67], v[196:199]
    ds_read_b64_tr_b16 v[48:49], v24 offset:32768
    v_mfma_f32_16x16x32_bf16 v[200:203], v[88:91], v[64:67], v[200:203]
    ds_read_b64_tr_b16 v[50:51], v24 offset:33792
    v_mfma_f32_16x16x32_bf16 v[204:207], v[92:95], v[64:67], v[204:207]
    ds_read_b128 v[36:39], v4 offset:51200
    v_mfma_f32_16x16x32_bf16 v[208:211], v[80:83], v[68:71], v[208:211]
    ds_read_b64_tr_b16 v[52:53], v25 offset:32768
    v_mfma_f32_16x16x32_bf16 v[212:215], v[84:87], v[68:71], v[212:215]
    ds_read_b64_tr_b16 v[54:55], v25 offset:33792
    v_mfma_f32_16x16x32_bf16 v[216:219], v[88:91], v[68:71], v[216:219]
    ds_read_b128 v[40:43], v4 offset:53248
    v_mfma_f32_16x16x32_bf16 v[220:223], v[92:95], v[68:71], v[220:223]
    ds_read_b64_tr_b16 v[56:57], v26 offset:32768
    v_mfma_f32_16x16x32_bf16 v[224:227], v[80:83], v[72:75], v[224:227]
    ds_read_b64_tr_b16 v[58:59], v26 offset:33792
    v_mfma_f32_16x16x32_bf16 v[228:231], v[84:87], v[72:75], v[228:231]
    ds_read_b128 v[44:47], v4 offset:55296
    v_mfma_f32_16x16x32_bf16 v[232:235], v[88:91], v[72:75], v[232:235]
    ds_read_b64_tr_b16 v[60:61], v27 offset:32768
    v_mfma_f32_16x16x32_bf16 v[236:239], v[92:95], v[72:75], v[236:239]
    ds_read_b64_tr_b16 v[62:63], v27 offset:33792
    v_mfma_f32_16x16x32_bf16 v[240:243], v[80:83], v[76:79], v[240:243]
    v_mfma_f32_16x16x32_bf16 v[244:247], v[84:87], v[76:79], v[244:247]
    v_mfma_f32_16x16x32_bf16 v[248:251], v[88:91], v[76:79], v[248:251]
    v_mfma_f32_16x16x32_bf16 v[252:255], v[92:95], v[76:79], v[252:255]
    s_waitcnt lgkmcnt(0)
    v_mfma_f32_16x16x32_bf16 v[192:195], v[48:51], v[32:35], v[192:195]
    ds_read_b128 v[64:67], v5 offset:49152
    v_mfma_f32_16x16x32_bf16 v[196:199], v[52:55], v[32:35], v[196:199]
    ds_read_b64_tr_b16 v[80:81], v24 offset:40960
    v_mfma_f32_16x16x32_bf16 v[200:203], v[56:59], v[32:35], v[200:203]
    ds_read_b64_tr_b16 v[82:83], v24 offset:41984
    v_mfma_f32_16x16x32_bf16 v[204:207], v[60:63], v[32:35], v[204:207]
    ds_read_b128 v[68:71], v5 offset:51200
    v_mfma_f32_16x16x32_bf16 v[208:211], v[48:51], v[36:39], v[208:211]
    ds_read_b64_tr_b16 v[84:85], v25 offset:40960
    v_mfma_f32_16x16x32_bf16 v[212:215], v[52:55], v[36:39], v[212:215]
    ds_read_b64_tr_b16 v[86:87], v25 offset:41984
    v_mfma_f32_16x16x32_bf16 v[216:219], v[56:59], v[36:39], v[216:219]
    ds_read_b128 v[72:75], v5 offset:53248
    v_mfma_f32_16x16x32_bf16 v[220:223], v[60:63], v[36:39], v[220:223]
    ds_read_b64_tr_b16 v[88:89], v26 offset:40960
    v_mfma_f32_16x16x32_bf16 v[224:227], v[48:51], v[40:43], v[224:227]
    ds_read_b64_tr_b16 v[90:91], v26 offset:41984
    v_mfma_f32_16x16x32_bf16 v[228:231], v[52:55], v[40:43], v[228:231]
    ds_read_b128 v[76:79], v5 offset:55296
    v_mfma_f32_16x16x32_bf16 v[232:235], v[56:59], v[40:43], v[232:235]
    ds_read_b64_tr_b16 v[92:93], v27 offset:40960
    v_mfma_f32_16x16x32_bf16 v[236:239], v[60:63], v[40:43], v[236:239]
    ds_read_b64_tr_b16 v[94:95], v27 offset:41984
    v_mfma_f32_16x16x32_bf16 v[240:243], v[48:51], v[44:47], v[240:243]
    v_mfma_f32_16x16x32_bf16 v[244:247], v[52:55], v[44:47], v[244:247]
    v_mfma_f32_16x16x32_bf16 v[248:251], v[56:59], v[44:47], v[248:251]
    v_mfma_f32_16x16x32_bf16 v[252:255], v[60:63], v[44:47], v[252:255]
    s_waitcnt vmcnt(2) lgkmcnt(0)
    s_barrier
    v_mfma_f32_16x16x32_bf16 v[192:195], v[80:83], v[64:67], v[192:195]
    ds_read_b128 v[32:35], v4 offset:0
    v_mfma_f32_16x16x32_bf16 v[196:199], v[84:87], v[64:67], v[196:199]
    ds_read_b64_tr_b16 v[48:49], v28 offset:0
    v_mfma_f32_16x16x32_bf16 v[200:203], v[88:91], v[64:67], v[200:203]
    ds_read_b64_tr_b16 v[50:51], v28 offset:1024
    v_mfma_f32_16x16x32_bf16 v[204:207], v[92:95], v[64:67], v[204:207]
    ds_read_b128 v[36:39], v4 offset:2048
    v_mfma_f32_16x16x32_bf16 v[208:211], v[80:83], v[68:71], v[208:211]
    ds_read_b64_tr_b16 v[52:53], v29 offset:0
    v_mfma_f32_16x16x32_bf16 v[212:215], v[84:87], v[68:71], v[212:215]
    ds_read_b64_tr_b16 v[54:55], v29 offset:1024
    v_mfma_f32_16x16x32_bf16 v[216:219], v[88:91], v[68:71], v[216:219]
    ds_read_b128 v[40:43], v4 offset:4096
    v_mfma_f32_16x16x32_bf16 v[220:223], v[92:95], v[68:71], v[220:223]
    ds_read_b64_tr_b16 v[56:57], v30 offset:0
    v_mfma_f32_16x16x32_bf16 v[224:227], v[80:83], v[72:75], v[224:227]
    ds_read_b64_tr_b16 v[58:59], v30 offset:1024
    v_mfma_f32_16x16x32_bf16 v[228:231], v[84:87], v[72:75], v[228:231]
    ds_read_b128 v[44:47], v4 offset:6144
    v_mfma_f32_16x16x32_bf16 v[232:235], v[88:91], v[72:75], v[232:235]
    ds_read_b64_tr_b16 v[60:61], v31 offset:0
    v_mfma_f32_16x16x32_bf16 v[236:239], v[92:95], v[72:75], v[236:239]
    ds_read_b64_tr_b16 v[62:63], v31 offset:1024
    v_mfma_f32_16x16x32_bf16 v[240:243], v[80:83], v[76:79], v[240:243]
    v_mfma_f32_16x16x32_bf16 v[244:247], v[84:87], v[76:79], v[244:247]
    v_mfma_f32_16x16x32_bf16 v[248:251], v[88:91], v[76:79], v[248:251]
    v_mfma_f32_16x16x32_bf16 v[252:255], v[92:95], v[76:79], v[252:255]
    s_waitcnt lgkmcnt(0)
    v_mfma_f32_16x16x32_bf16 v[192:195], v[48:51], v[32:35], v[192:195]
    ds_read_b128 v[64:67], v5 offset:0
    v_mfma_f32_16x16x32_bf16 v[196:199], v[52:55], v[32:35], v[196:199]
    ds_read_b64_tr_b16 v[80:81], v28 offset:8192
    v_mfma_f32_16x16x32_bf16 v[200:203], v[56:59], v[32:35], v[200:203]
    ds_read_b64_tr_b16 v[82:83], v28 offset:9216
    v_mfma_f32_16x16x32_bf16 v[204:207], v[60:63], v[32:35], v[204:207]
    ds_read_b128 v[68:71], v5 offset:2048
    v_mfma_f32_16x16x32_bf16 v[208:211], v[48:51], v[36:39], v[208:211]
    ds_read_b64_tr_b16 v[84:85], v29 offset:8192
    v_mfma_f32_16x16x32_bf16 v[212:215], v[52:55], v[36:39], v[212:215]
    ds_read_b64_tr_b16 v[86:87], v29 offset:9216
    v_mfma_f32_16x16x32_bf16 v[216:219], v[56:59], v[36:39], v[216:219]
    ds_read_b128 v[72:75], v5 offset:4096
    v_mfma_f32_16x16x32_bf16 v[220:223], v[60:63], v[36:39], v[220:223]
    ds_read_b64_tr_b16 v[88:89], v30 offset:8192
    v_mfma_f32_16x16x32_bf16 v[224:227], v[48:51], v[40:43], v[224:227]
    ds_read_b64_tr_b16 v[90:91], v30 offset:9216
    v_mfma_f32_16x16x32_bf16 v[228:231], v[52:55], v[40:43], v[228:231]
    ds_read_b128 v[76:79], v5 offset:6144
    v_mfma_f32_16x16x32_bf16 v[232:235], v[56:59], v[40:43], v[232:235]
    ds_read_b64_tr_b16 v[92:93], v31 offset:8192
    v_mfma_f32_16x16x32_bf16 v[236:239], v[60:63], v[40:43], v[236:239]
    ds_read_b64_tr_b16 v[94:95], v31 offset:9216
    v_mfma_f32_16x16x32_bf16 v[240:243], v[48:51], v[44:47], v[240:243]
    v_mfma_f32_16x16x32_bf16 v[244:247], v[52:55], v[44:47], v[244:247]
    v_mfma_f32_16x16x32_bf16 v[248:251], v[56:59], v[44:47], v[248:251]
    v_mfma_f32_16x16x32_bf16 v[252:255], v[60:63], v[44:47], v[252:255]
    s_waitcnt lgkmcnt(0)
    s_barrier
    v_mfma_f32_16x16x32_bf16 v[192:195], v[80:83], v[64:67], v[192:195]
    ds_read_b128 v[32:35], v4 offset:16384
    v_mfma_f32_16x16x32_bf16 v[196:199], v[84:87], v[64:67], v[196:199]
    ds_read_b64_tr_b16 v[48:49], v24 offset:0
    v_mfma_f32_16x16x32_bf16 v[200:203], v[88:91], v[64:67], v[200:203]
    ds_read_b64_tr_b16 v[50:51], v24 offset:1024
    v_mfma_f32_16x16x32_bf16 v[204:207], v[92:95], v[64:67], v[204:207]
    ds_read_b128 v[36:39], v4 offset:18432
    v_mfma_f32_16x16x32_bf16 v[208:211], v[80:83], v[68:71], v[208:211]
    ds_read_b64_tr_b16 v[52:53], v25 offset:0
    v_mfma_f32_16x16x32_bf16 v[212:215], v[84:87], v[68:71], v[212:215]
    ds_read_b64_tr_b16 v[54:55], v25 offset:1024
    v_mfma_f32_16x16x32_bf16 v[216:219], v[88:91], v[68:71], v[216:219]
    ds_read_b128 v[40:43], v4 offset:20480
    v_mfma_f32_16x16x32_bf16 v[220:223], v[92:95], v[68:71], v[220:223]
    ds_read_b64_tr_b16 v[56:57], v26 offset:0
    v_mfma_f32_16x16x32_bf16 v[224:227], v[80:83], v[72:75], v[224:227]
    ds_read_b64_tr_b16 v[58:59], v26 offset:1024
    v_mfma_f32_16x16x32_bf16 v[228:231], v[84:87], v[72:75], v[228:231]
    ds_read_b128 v[44:47], v4 offset:22528
    v_mfma_f32_16x16x32_bf16 v[232:235], v[88:91], v[72:75], v[232:235]
    ds_read_b64_tr_b16 v[60:61], v27 offset:0
    v_mfma_f32_16x16x32_bf16 v[236:239], v[92:95], v[72:75], v[236:239]
    ds_read_b64_tr_b16 v[62:63], v27 offset:1024
    v_mfma_f32_16x16x32_bf16 v[240:243], v[80:83], v[76:79], v[240:243]
    v_mfma_f32_16x16x32_bf16 v[244:247], v[84:87], v[76:79], v[244:247]
    v_mfma_f32_16x16x32_bf16 v[248:251], v[88:91], v[76:79], v[248:251]
    v_mfma_f32_16x16x32_bf16 v[252:255], v[92:95], v[76:79], v[252:255]
    s_waitcnt lgkmcnt(0)
    v_mfma_f32_16x16x32_bf16 v[192:195], v[48:51], v[32:35], v[192:195]
    ds_read_b128 v[64:67], v5 offset:16384
    v_mfma_f32_16x16x32_bf16 v[196:199], v[52:55], v[32:35], v[196:199]
    ds_read_b64_tr_b16 v[80:81], v24 offset:8192
    v_mfma_f32_16x16x32_bf16 v[200:203], v[56:59], v[32:35], v[200:203]
    ds_read_b64_tr_b16 v[82:83], v24 offset:9216
    v_mfma_f32_16x16x32_bf16 v[204:207], v[60:63], v[32:35], v[204:207]
    ds_read_b128 v[68:71], v5 offset:18432
    v_mfma_f32_16x16x32_bf16 v[208:211], v[48:51], v[36:39], v[208:211]
    ds_read_b64_tr_b16 v[84:85], v25 offset:8192
    v_mfma_f32_16x16x32_bf16 v[212:215], v[52:55], v[36:39], v[212:215]
    ds_read_b64_tr_b16 v[86:87], v25 offset:9216
    v_mfma_f32_16x16x32_bf16 v[216:219], v[56:59], v[36:39], v[216:219]
    ds_read_b128 v[72:75], v5 offset:20480
    v_mfma_f32_16x16x32_bf16 v[220:223], v[60:63], v[36:39], v[220:223]
    ds_read_b64_tr_b16 v[88:89], v26 offset:8192
    v_mfma_f32_16x16x32_bf16 v[224:227], v[48:51], v[40:43], v[224:227]
    ds_read_b64_tr_b16 v[90:91], v26 offset:9216
    v_mfma_f32_16x16x32_bf16 v[228:231], v[52:55], v[40:43], v[228:231]
    ds_read_b128 v[76:79], v5 offset:22528
    v_mfma_f32_16x16x32_bf16 v[232:235], v[56:59], v[40:43], v[232:235]
    ds_read_b64_tr_b16 v[92:93], v27 offset:8192
    v_mfma_f32_16x16x32_bf16 v[236:239], v[60:63], v[40:43], v[236:239]
    ds_read_b64_tr_b16 v[94:95], v27 offset:9216
    v_mfma_f32_16x16x32_bf16 v[240:243], v[48:51], v[44:47], v[240:243]
    v_mfma_f32_16x16x32_bf16 v[244:247], v[52:55], v[44:47], v[244:247]
    v_mfma_f32_16x16x32_bf16 v[248:251], v[56:59], v[44:47], v[248:251]
    v_mfma_f32_16x16x32_bf16 v[252:255], v[60:63], v[44:47], v[252:255]
    s_waitcnt lgkmcnt(0)
    s_barrier
    v_mfma_f32_16x16x32_bf16 v[192:195], v[80:83], v[64:67], v[192:195]
    ds_read_b128 v[32:35], v4 offset:49152
    v_mfma_f32_16x16x32_bf16 v[196:199], v[84:87], v[64:67], v[196:199]
    ds_read_b64_tr_b16 v[48:49], v24 offset:32768
    v_mfma_f32_16x16x32_bf16 v[200:203], v[88:91], v[64:67], v[200:203]
    ds_read_b64_tr_b16 v[50:51], v24 offset:33792
    v_mfma_f32_16x16x32_bf16 v[204:207], v[92:95], v[64:67], v[204:207]
    ds_read_b128 v[36:39], v4 offset:51200
    v_mfma_f32_16x16x32_bf16 v[208:211], v[80:83], v[68:71], v[208:211]
    ds_read_b64_tr_b16 v[52:53], v25 offset:32768
    v_mfma_f32_16x16x32_bf16 v[212:215], v[84:87], v[68:71], v[212:215]
    ds_read_b64_tr_b16 v[54:55], v25 offset:33792
    v_mfma_f32_16x16x32_bf16 v[216:219], v[88:91], v[68:71], v[216:219]
    ds_read_b128 v[40:43], v4 offset:53248
    v_mfma_f32_16x16x32_bf16 v[220:223], v[92:95], v[68:71], v[220:223]
    ds_read_b64_tr_b16 v[56:57], v26 offset:32768
    v_mfma_f32_16x16x32_bf16 v[224:227], v[80:83], v[72:75], v[224:227]
    ds_read_b64_tr_b16 v[58:59], v26 offset:33792
    v_mfma_f32_16x16x32_bf16 v[228:231], v[84:87], v[72:75], v[228:231]
    ds_read_b128 v[44:47], v4 offset:55296
    v_mfma_f32_16x16x32_bf16 v[232:235], v[88:91], v[72:75], v[232:235]
    ds_read_b64_tr_b16 v[60:61], v27 offset:32768
    v_mfma_f32_16x16x32_bf16 v[236:239], v[92:95], v[72:75], v[236:239]
    ds_read_b64_tr_b16 v[62:63], v27 offset:33792
    v_mfma_f32_16x16x32_bf16 v[240:243], v[80:83], v[76:79], v[240:243]
    v_mfma_f32_16x16x32_bf16 v[244:247], v[84:87], v[76:79], v[244:247]
    v_mfma_f32_16x16x32_bf16 v[248:251], v[88:91], v[76:79], v[248:251]
    v_mfma_f32_16x16x32_bf16 v[252:255], v[92:95], v[76:79], v[252:255]
    s_waitcnt lgkmcnt(0)
    v_mfma_f32_16x16x32_bf16 v[192:195], v[48:51], v[32:35], v[192:195]
    ds_read_b128 v[64:67], v5 offset:49152
    v_mfma_f32_16x16x32_bf16 v[196:199], v[52:55], v[32:35], v[196:199]
    ds_read_b64_tr_b16 v[80:81], v24 offset:40960
    v_mfma_f32_16x16x32_bf16 v[200:203], v[56:59], v[32:35], v[200:203]
    ds_read_b64_tr_b16 v[82:83], v24 offset:41984
    v_mfma_f32_16x16x32_bf16 v[204:207], v[60:63], v[32:35], v[204:207]
    ds_read_b128 v[68:71], v5 offset:51200
    v_mfma_f32_16x16x32_bf16 v[208:211], v[48:51], v[36:39], v[208:211]
    ds_read_b64_tr_b16 v[84:85], v25 offset:40960
    v_mfma_f32_16x16x32_bf16 v[212:215], v[52:55], v[36:39], v[212:215]
    ds_read_b64_tr_b16 v[86:87], v25 offset:41984
    v_mfma_f32_16x16x32_bf16 v[216:219], v[56:59], v[36:39], v[216:219]
    ds_read_b128 v[72:75], v5 offset:53248
    v_mfma_f32_16x16x32_bf16 v[220:223], v[60:63], v[36:39], v[220:223]
    ds_read_b64_tr_b16 v[88:89], v26 offset:40960
    v_mfma_f32_16x16x32_bf16 v[224:227], v[48:51], v[40:43], v[224:227]
    ds_read_b64_tr_b16 v[90:91], v26 offset:41984
    v_mfma_f32_16x16x32_bf16 v[228:231], v[52:55], v[40:43], v[228:231]
    ds_read_b128 v[76:79], v5 offset:55296
    v_mfma_f32_16x16x32_bf16 v[232:235], v[56:59], v[40:43], v[232:235]
    ds_read_b64_tr_b16 v[92:93], v27 offset:40960
    v_mfma_f32_16x16x32_bf16 v[236:239], v[60:63], v[40:43], v[236:239]
    ds_read_b64_tr_b16 v[94:95], v27 offset:41984
    v_mfma_f32_16x16x32_bf16 v[240:243], v[48:51], v[44:47], v[240:243]
    v_mfma_f32_16x16x32_bf16 v[244:247], v[52:55], v[44:47], v[244:247]
    v_mfma_f32_16x16x32_bf16 v[248:251], v[56:59], v[44:47], v[248:251]
    v_mfma_f32_16x16x32_bf16 v[252:255], v[60:63], v[44:47], v[252:255]
    s_waitcnt lgkmcnt(0)
    s_barrier
    v_mfma_f32_16x16x32_bf16 v[192:195], v[80:83], v[64:67], v[192:195]
    ds_read_b128 v[32:35], v4 offset:0
    v_mfma_f32_16x16x32_bf16 v[196:199], v[84:87], v[64:67], v[196:199]
    ds_read_b64_tr_b16 v[48:49], v28 offset:0
    v_mfma_f32_16x16x32_bf16 v[200:203], v[88:91], v[64:67], v[200:203]
    ds_read_b64_tr_b16 v[50:51], v28 offset:1024
    v_mfma_f32_16x16x32_bf16 v[204:207], v[92:95], v[64:67], v[204:207]
    ds_read_b128 v[36:39], v4 offset:2048
    v_mfma_f32_16x16x32_bf16 v[208:211], v[80:83], v[68:71], v[208:211]
    ds_read_b64_tr_b16 v[52:53], v29 offset:0
    v_mfma_f32_16x16x32_bf16 v[212:215], v[84:87], v[68:71], v[212:215]
    ds_read_b64_tr_b16 v[54:55], v29 offset:1024
    v_mfma_f32_16x16x32_bf16 v[216:219], v[88:91], v[68:71], v[216:219]
    ds_read_b128 v[40:43], v4 offset:4096
    v_mfma_f32_16x16x32_bf16 v[220:223], v[92:95], v[68:71], v[220:223]
    ds_read_b64_tr_b16 v[56:57], v30 offset:0
    v_mfma_f32_16x16x32_bf16 v[224:227], v[80:83], v[72:75], v[224:227]
    ds_read_b64_tr_b16 v[58:59], v30 offset:1024
    v_mfma_f32_16x16x32_bf16 v[228:231], v[84:87], v[72:75], v[228:231]
    ds_read_b128 v[44:47], v4 offset:6144
    v_mfma_f32_16x16x32_bf16 v[232:235], v[88:91], v[72:75], v[232:235]
    ds_read_b64_tr_b16 v[60:61], v31 offset:0
    v_mfma_f32_16x16x32_bf16 v[236:239], v[92:95], v[72:75], v[236:239]
    ds_read_b64_tr_b16 v[62:63], v31 offset:1024
    v_mfma_f32_16x16x32_bf16 v[240:243], v[80:83], v[76:79], v[240:243]
    v_mfma_f32_16x16x32_bf16 v[244:247], v[84:87], v[76:79], v[244:247]
    v_mfma_f32_16x16x32_bf16 v[248:251], v[88:91], v[76:79], v[248:251]
    v_mfma_f32_16x16x32_bf16 v[252:255], v[92:95], v[76:79], v[252:255]
    s_waitcnt lgkmcnt(0)
    v_mfma_f32_16x16x32_bf16 v[192:195], v[48:51], v[32:35], v[192:195]
    ds_read_b128 v[64:67], v5 offset:0
    v_mfma_f32_16x16x32_bf16 v[196:199], v[52:55], v[32:35], v[196:199]
    ds_read_b64_tr_b16 v[80:81], v28 offset:8192
    v_mfma_f32_16x16x32_bf16 v[200:203], v[56:59], v[32:35], v[200:203]
    ds_read_b64_tr_b16 v[82:83], v28 offset:9216
    v_mfma_f32_16x16x32_bf16 v[204:207], v[60:63], v[32:35], v[204:207]
    ds_read_b128 v[68:71], v5 offset:2048
    v_mfma_f32_16x16x32_bf16 v[208:211], v[48:51], v[36:39], v[208:211]
    ds_read_b64_tr_b16 v[84:85], v29 offset:8192
    v_mfma_f32_16x16x32_bf16 v[212:215], v[52:55], v[36:39], v[212:215]
    ds_read_b64_tr_b16 v[86:87], v29 offset:9216
    v_mfma_f32_16x16x32_bf16 v[216:219], v[56:59], v[36:39], v[216:219]
    ds_read_b128 v[72:75], v5 offset:4096
    v_mfma_f32_16x16x32_bf16 v[220:223], v[60:63], v[36:39], v[220:223]
    ds_read_b64_tr_b16 v[88:89], v30 offset:8192
    v_mfma_f32_16x16x32_bf16 v[224:227], v[48:51], v[40:43], v[224:227]
    ds_read_b64_tr_b16 v[90:91], v30 offset:9216
    v_mfma_f32_16x16x32_bf16 v[228:231], v[52:55], v[40:43], v[228:231]
    ds_read_b128 v[76:79], v5 offset:6144
    v_mfma_f32_16x16x32_bf16 v[232:235], v[56:59], v[40:43], v[232:235]
    ds_read_b64_tr_b16 v[92:93], v31 offset:8192
    v_mfma_f32_16x16x32_bf16 v[236:239], v[60:63], v[40:43], v[236:239]
    ds_read_b64_tr_b16 v[94:95], v31 offset:9216
    v_mfma_f32_16x16x32_bf16 v[240:243], v[48:51], v[44:47], v[240:243]
    v_mfma_f32_16x16x32_bf16 v[244:247], v[52:55], v[44:47], v[244:247]
    v_mfma_f32_16x16x32_bf16 v[248:251], v[56:59], v[44:47], v[248:251]
    v_mfma_f32_16x16x32_bf16 v[252:255], v[60:63], v[44:47], v[252:255]
    s_waitcnt lgkmcnt(0)
    s_barrier
    v_mfma_f32_16x16x32_bf16 v[192:195], v[80:83], v[64:67], v[192:195]
    ds_read_b128 v[32:35], v4 offset:16384
    v_mfma_f32_16x16x32_bf16 v[196:199], v[84:87], v[64:67], v[196:199]
    ds_read_b64_tr_b16 v[48:49], v24 offset:0
    v_mfma_f32_16x16x32_bf16 v[200:203], v[88:91], v[64:67], v[200:203]
    ds_read_b64_tr_b16 v[50:51], v24 offset:1024
    s_add_u32 m0, s76, 0
    v_mfma_f32_16x16x32_bf16 v[204:207], v[92:95], v[64:67], v[204:207]
    ds_read_b128 v[36:39], v4 offset:18432
    v_mfma_f32_16x16x32_bf16 v[208:211], v[80:83], v[68:71], v[208:211]
    ds_read_b64_tr_b16 v[52:53], v25 offset:0
    v_mfma_f32_16x16x32_bf16 v[212:215], v[84:87], v[68:71], v[212:215]
    ds_read_b64_tr_b16 v[54:55], v25 offset:1024
    s_add_u32 s14, s36, 0
    v_mfma_f32_16x16x32_bf16 v[216:219], v[88:91], v[68:71], v[216:219]
    ds_read_b128 v[40:43], v4 offset:20480
    v_mfma_f32_16x16x32_bf16 v[220:223], v[92:95], v[68:71], v[220:223]
    ds_read_b64_tr_b16 v[56:57], v26 offset:0
    v_mfma_f32_16x16x32_bf16 v[224:227], v[80:83], v[72:75], v[224:227]
    ds_read_b64_tr_b16 v[58:59], v26 offset:1024
    buffer_load_dwordx4 v10, s[56:59], s14 offen lds
    v_mfma_f32_16x16x32_bf16 v[228:231], v[84:87], v[72:75], v[228:231]
    ds_read_b128 v[44:47], v4 offset:22528
    v_mfma_f32_16x16x32_bf16 v[232:235], v[88:91], v[72:75], v[232:235]
    ds_read_b64_tr_b16 v[60:61], v27 offset:0
    v_mfma_f32_16x16x32_bf16 v[236:239], v[92:95], v[72:75], v[236:239]
    ds_read_b64_tr_b16 v[62:63], v27 offset:1024
    buffer_load_dwordx4 v11, s[56:59], s14 offen offset:1024 lds
    v_mfma_f32_16x16x32_bf16 v[240:243], v[80:83], v[76:79], v[240:243]
    s_add_u32 m0, s76, 8192
    v_mfma_f32_16x16x32_bf16 v[244:247], v[84:87], v[76:79], v[244:247]
    s_add_u32 s14, s36, 16384
    v_mfma_f32_16x16x32_bf16 v[248:251], v[88:91], v[76:79], v[248:251]
    buffer_load_dwordx4 v10, s[56:59], s14 offen lds
    v_mfma_f32_16x16x32_bf16 v[252:255], v[92:95], v[76:79], v[252:255]
    buffer_load_dwordx4 v11, s[56:59], s14 offen offset:1024 lds
    s_waitcnt lgkmcnt(0)
    v_mfma_f32_16x16x32_bf16 v[192:195], v[48:51], v[32:35], v[192:195]
    ds_read_b128 v[64:67], v5 offset:16384
    v_mfma_f32_16x16x32_bf16 v[196:199], v[52:55], v[32:35], v[196:199]
    ds_read_b64_tr_b16 v[80:81], v24 offset:8192
    v_mfma_f32_16x16x32_bf16 v[200:203], v[56:59], v[32:35], v[200:203]
    ds_read_b64_tr_b16 v[82:83], v24 offset:9216
    s_add_u32 m0, s76, 16384
    v_mfma_f32_16x16x32_bf16 v[204:207], v[60:63], v[32:35], v[204:207]
    ds_read_b128 v[68:71], v5 offset:18432
    v_mfma_f32_16x16x32_bf16 v[208:211], v[48:51], v[36:39], v[208:211]
    ds_read_b64_tr_b16 v[84:85], v25 offset:8192
    v_mfma_f32_16x16x32_bf16 v[212:215], v[52:55], v[36:39], v[212:215]
    ds_read_b64_tr_b16 v[86:87], v25 offset:9216
    s_add_u32 s14, s36, 32768
    v_mfma_f32_16x16x32_bf16 v[216:219], v[56:59], v[36:39], v[216:219]
    ds_read_b128 v[72:75], v5 offset:20480
    v_mfma_f32_16x16x32_bf16 v[220:223], v[60:63], v[36:39], v[220:223]
    ds_read_b64_tr_b16 v[88:89], v26 offset:8192
    v_mfma_f32_16x16x32_bf16 v[224:227], v[48:51], v[40:43], v[224:227]
    ds_read_b64_tr_b16 v[90:91], v26 offset:9216
    buffer_load_dwordx4 v10, s[56:59], s14 offen lds
    v_mfma_f32_16x16x32_bf16 v[228:231], v[52:55], v[40:43], v[228:231]
    ds_read_b128 v[76:79], v5 offset:22528
    v_mfma_f32_16x16x32_bf16 v[232:235], v[56:59], v[40:43], v[232:235]
    ds_read_b64_tr_b16 v[92:93], v27 offset:8192
    v_mfma_f32_16x16x32_bf16 v[236:239], v[60:63], v[40:43], v[236:239]
    ds_read_b64_tr_b16 v[94:95], v27 offset:9216
    buffer_load_dwordx4 v11, s[56:59], s14 offen offset:1024 lds
    v_mfma_f32_16x16x32_bf16 v[240:243], v[48:51], v[44:47], v[240:243]
    s_add_u32 m0, s76, 24576
    v_mfma_f32_16x16x32_bf16 v[244:247], v[52:55], v[44:47], v[244:247]
    s_add_u32 s14, s36, 49152
    v_mfma_f32_16x16x32_bf16 v[248:251], v[56:59], v[44:47], v[248:251]
    buffer_load_dwordx4 v10, s[56:59], s14 offen lds
    v_mfma_f32_16x16x32_bf16 v[252:255], v[60:63], v[44:47], v[252:255]
    buffer_load_dwordx4 v11, s[56:59], s14 offen offset:1024 lds
    s_waitcnt lgkmcnt(0)
    s_barrier
    v_mfma_f32_16x16x32_bf16 v[192:195], v[80:83], v[64:67], v[192:195]
    ds_read_b128 v[32:35], v4 offset:49152
    v_mfma_f32_16x16x32_bf16 v[196:199], v[84:87], v[64:67], v[196:199]
    ds_read_b64_tr_b16 v[48:49], v24 offset:32768
    v_mfma_f32_16x16x32_bf16 v[200:203], v[88:91], v[64:67], v[200:203]
    ds_read_b64_tr_b16 v[50:51], v24 offset:33792
    s_add_u32 m0, s76, 32768
    v_mfma_f32_16x16x32_bf16 v[204:207], v[92:95], v[64:67], v[204:207]
    ds_read_b128 v[36:39], v4 offset:51200
    v_mfma_f32_16x16x32_bf16 v[208:211], v[80:83], v[68:71], v[208:211]
    ds_read_b64_tr_b16 v[52:53], v25 offset:32768
    v_mfma_f32_16x16x32_bf16 v[212:215], v[84:87], v[68:71], v[212:215]
    ds_read_b64_tr_b16 v[54:55], v25 offset:33792
    s_add_u32 s14, s36, 65536
    v_mfma_f32_16x16x32_bf16 v[216:219], v[88:91], v[68:71], v[216:219]
    ds_read_b128 v[40:43], v4 offset:53248
    v_mfma_f32_16x16x32_bf16 v[220:223], v[92:95], v[68:71], v[220:223]
    ds_read_b64_tr_b16 v[56:57], v26 offset:32768
    v_mfma_f32_16x16x32_bf16 v[224:227], v[80:83], v[72:75], v[224:227]
    ds_read_b64_tr_b16 v[58:59], v26 offset:33792
    buffer_load_dwordx4 v10, s[56:59], s14 offen lds
    v_mfma_f32_16x16x32_bf16 v[228:231], v[84:87], v[72:75], v[228:231]
    ds_read_b128 v[44:47], v4 offset:55296
    v_mfma_f32_16x16x32_bf16 v[232:235], v[88:91], v[72:75], v[232:235]
    ds_read_b64_tr_b16 v[60:61], v27 offset:32768
    v_mfma_f32_16x16x32_bf16 v[236:239], v[92:95], v[72:75], v[236:239]
    ds_read_b64_tr_b16 v[62:63], v27 offset:33792
    buffer_load_dwordx4 v11, s[56:59], s14 offen offset:1024 lds
    v_mfma_f32_16x16x32_bf16 v[240:243], v[80:83], v[76:79], v[240:243]
    s_add_u32 m0, s76, 40960
    v_mfma_f32_16x16x32_bf16 v[244:247], v[84:87], v[76:79], v[244:247]
    s_add_u32 s14, s36, 81920
    v_mfma_f32_16x16x32_bf16 v[248:251], v[88:91], v[76:79], v[248:251]
    buffer_load_dwordx4 v10, s[56:59], s14 offen lds
    v_mfma_f32_16x16x32_bf16 v[252:255], v[92:95], v[76:79], v[252:255]
    buffer_load_dwordx4 v11, s[56:59], s14 offen offset:1024 lds
    ds_read_b128 v[64:67], v5 offset:49152
    ds_read_b64_tr_b16 v[80:81], v24 offset:40960
    ds_read_b64_tr_b16 v[82:83], v24 offset:41984
    ds_read_b128 v[68:71], v5 offset:51200
    ds_read_b64_tr_b16 v[84:85], v25 offset:40960
    ds_read_b64_tr_b16 v[86:87], v25 offset:41984
    ds_read_b128 v[72:75], v5 offset:53248
    ds_read_b64_tr_b16 v[88:89], v26 offset:40960
    ds_read_b64_tr_b16 v[90:91], v26 offset:41984
    ds_read_b128 v[76:79], v5 offset:55296
    ds_read_b64_tr_b16 v[92:93], v27 offset:40960
    ds_read_b64_tr_b16 v[94:95], v27 offset:41984
    s_waitcnt lgkmcnt(12)
    v_mfma_f32_16x16x32_bf16 v[192:195], v[48:51], v[32:35], v[192:195]
    v_mfma_f32_16x16x32_bf16 v[196:199], v[52:55], v[32:35], v[196:199]
    v_mfma_f32_16x16x32_bf16 v[200:203], v[56:59], v[32:35], v[200:203]
    v_mfma_f32_16x16x32_bf16 v[204:207], v[60:63], v[32:35], v[204:207]
    s_waitcnt lgkmcnt(0)
    s_mov_b64 exec, 1
    ds_add_u32 v3, v9 offset:64388
    s_mov_b64 exec, -1
    v_mfma_f32_16x16x32_bf16 v[192:195], v[80:83], v[64:67], v[192:195]
    v_mfma_f32_16x16x32_bf16 v[196:199], v[84:87], v[64:67], v[196:199]
    v_mfma_f32_16x16x32_bf16 v[200:203], v[88:91], v[64:67], v[200:203]
    v_mfma_f32_16x16x32_bf16 v[204:207], v[92:95], v[64:67], v[204:207]
    v_mfma_f32_16x16x32_bf16 v[208:211], v[48:51], v[36:39], v[208:211]
    v_mfma_f32_16x16x32_bf16 v[212:215], v[52:55], v[36:39], v[212:215]
    s_nop 2
    v_cvt_pk_bf16_f32 v160, v192, v193
    v_cvt_pk_bf16_f32 v161, v194, v195
    v_cvt_pk_bf16_f32 v162, v196, v197
    v_mfma_f32_16x16x32_bf16 v[216:219], v[56:59], v[36:39], v[216:219]
    v_cvt_pk_bf16_f32 v163, v198, v199
    v_pk_max_i16 v160, v160, 0
    v_pk_max_i16 v161, v161, 0
    v_mfma_f32_16x16x32_bf16 v[220:223], v[60:63], v[36:39], v[220:223]
    v_pk_max_i16 v162, v162, 0
    v_pk_max_i16 v163, v163, 0
    buffer_store_dwordx4 v[160:163], v7, s[64:67], s32 offen offset:0 sc1
    v_mfma_f32_16x16x32_bf16 v[208:211], v[80:83], v[68:71], v[208:211]
    v_cvt_pk_bf16_f32 v164, v200, v201
    v_cvt_pk_bf16_f32 v165, v202, v203
    v_cvt_pk_bf16_f32 v166, v204, v205
    v_mfma_f32_16x16x32_bf16 v[212:215], v[84:87], v[68:71], v[212:215]
    v_cvt_pk_bf16_f32 v167, v206, v207
    v_pk_max_i16 v164, v164, 0
    v_pk_max_i16 v165, v165, 0
    v_mfma_f32_16x16x32_bf16 v[216:219], v[88:91], v[68:71], v[216:219]
    v_pk_max_i16 v166, v166, 0
    v_pk_max_i16 v167, v167, 0
    buffer_store_dwordx4 v[164:167], v7, s[64:67], s32 offen offset:1024 sc1
    v_mfma_f32_16x16x32_bf16 v[220:223], v[92:95], v[68:71], v[220:223]
    v_mfma_f32_16x16x32_bf16 v[224:227], v[48:51], v[40:43], v[224:227]
    v_mfma_f32_16x16x32_bf16 v[228:231], v[52:55], v[40:43], v[228:231]
    s_add_u32 s32, s32, 28672
    v_cvt_pk_bf16_f32 v168, v208, v209
    v_cvt_pk_bf16_f32 v169, v210, v211
    v_mfma_f32_16x16x32_bf16 v[232:235], v[56:59], v[40:43], v[232:235]
    v_cvt_pk_bf16_f32 v170, v212, v213
    v_cvt_pk_bf16_f32 v171, v214, v215
    v_pk_max_i16 v168, v168, 0
    v_mfma_f32_16x16x32_bf16 v[236:239], v[60:63], v[40:43], v[236:239]
    v_pk_max_i16 v169, v169, 0
    v_pk_max_i16 v170, v170, 0
    v_pk_max_i16 v171, v171, 0
    v_mfma_f32_16x16x32_bf16 v[224:227], v[80:83], v[72:75], v[224:227]
    buffer_store_dwordx4 v[168:171], v7, s[64:67], s32 offen offset:0 sc1
    v_cvt_pk_bf16_f32 v172, v216, v217
    v_cvt_pk_bf16_f32 v173, v218, v219
    v_mfma_f32_16x16x32_bf16 v[228:231], v[84:87], v[72:75], v[228:231]
    v_cvt_pk_bf16_f32 v174, v220, v221
    v_cvt_pk_bf16_f32 v175, v222, v223
    v_pk_max_i16 v172, v172, 0
    v_mfma_f32_16x16x32_bf16 v[232:235], v[88:91], v[72:75], v[232:235]
    v_pk_max_i16 v173, v173, 0
    v_pk_max_i16 v174, v174, 0
    v_pk_max_i16 v175, v175, 0
    v_mfma_f32_16x16x32_bf16 v[236:239], v[92:95], v[72:75], v[236:239]
    buffer_store_dwordx4 v[172:175], v7, s[64:67], s32 offen offset:1024 sc1
    v_mfma_f32_16x16x32_bf16 v[240:243], v[48:51], v[44:47], v[240:243]
    v_mfma_f32_16x16x32_bf16 v[244:247], v[52:55], v[44:47], v[244:247]
    s_add_u32 s32, s32, 28672
    v_cvt_pk_bf16_f32 v176, v224, v225
    v_cvt_pk_bf16_f32 v177, v226, v227
    v_mfma_f32_16x16x32_bf16 v[248:251], v[56:59], v[44:47], v[248:251]
    v_cvt_pk_bf16_f32 v178, v228, v229
    v_cvt_pk_bf16_f32 v179, v230, v231
    v_pk_max_i16 v176, v176, 0
    v_mfma_f32_16x16x32_bf16 v[252:255], v[60:63], v[44:47], v[252:255]
    v_pk_max_i16 v177, v177, 0
    v_pk_max_i16 v178, v178, 0
    v_pk_max_i16 v179, v179, 0
    v_mfma_f32_16x16x32_bf16 v[240:243], v[80:83], v[76:79], v[240:243]
    buffer_store_dwordx4 v[176:179], v7, s[64:67], s32 offen offset:0 sc1
    v_cvt_pk_bf16_f32 v180, v232, v233
    v_cvt_pk_bf16_f32 v181, v234, v235
    v_mfma_f32_16x16x32_bf16 v[244:247], v[84:87], v[76:79], v[244:247]
    v_cvt_pk_bf16_f32 v182, v236, v237
    v_cvt_pk_bf16_f32 v183, v238, v239
    v_pk_max_i16 v180, v180, 0
    v_mfma_f32_16x16x32_bf16 v[248:251], v[88:91], v[76:79], v[248:251]
    v_pk_max_i16 v181, v181, 0
    v_pk_max_i16 v182, v182, 0
    v_pk_max_i16 v183, v183, 0
    v_mfma_f32_16x16x32_bf16 v[252:255], v[92:95], v[76:79], v[252:255]
    buffer_store_dwordx4 v[180:183], v7, s[64:67], s32 offen offset:1024 sc1
    s_add_u32 s32, s32, 28672
    v_cvt_pk_bf16_f32 v184, v240, v241
    v_cvt_pk_bf16_f32 v185, v242, v243
    v_cvt_pk_bf16_f32 v186, v244, v245
    v_cvt_pk_bf16_f32 v187, v246, v247
    v_pk_max_i16 v184, v184, 0
    v_pk_max_i16 v185, v185, 0
    v_pk_max_i16 v186, v186, 0
    v_pk_max_i16 v187, v187, 0
    buffer_store_dwordx4 v[184:187], v7, s[64:67], s32 offen offset:0 sc1
    v_cvt_pk_bf16_f32 v188, v248, v249
    v_cvt_pk_bf16_f32 v189, v250, v251
    v_cvt_pk_bf16_f32 v190, v252, v253
    v_cvt_pk_bf16_f32 v191, v254, v255
    v_pk_max_i16 v188, v188, 0
    v_pk_max_i16 v189, v189, 0
    v_pk_max_i16 v190, v190, 0
    v_pk_max_i16 v191, v191, 0
    buffer_store_dwordx4 v[188:191], v7, s[64:67], s32 offen offset:1024 sc1
    v_lshrrev_b32 v8, 2, v1
    v_lshl_add_u32 v9, v8, 7, s76
    v_bfe_u32 v8, v1, 3, 2
    v_lshl_add_u32 v9, v8, 5, v9
    v_and_b32 v8, 3, v1
    v_lshl_add_u32 v24, v8, 3, v9
    v_xor_b32 v25, 32, v24
    v_xor_b32 v26, 64, v24
    v_xor_b32 v27, 96, v24
    v_add_u32 v2, 0x10000, v24
    v_xor_b32 v5, 32, v2
    v_xor_b32 v22, 64, v2
    v_xor_b32 v23, 96, v2
    s_waitcnt vmcnt(18)
    ds_read_b64_tr_b16 v[96:97], v24 offset:0
    ds_read_b64_tr_b16 v[100:101], v25 offset:0
    ds_read_b64_tr_b16 v[104:105], v26 offset:0
    ds_read_b64_tr_b16 v[108:109], v27 offset:0
    s_waitcnt vmcnt(16)
    ds_read_b64_tr_b16 v[98:99], v24 offset:8192
    ds_read_b64_tr_b16 v[102:103], v25 offset:8192
    ds_read_b64_tr_b16 v[106:107], v26 offset:8192
    ds_read_b64_tr_b16 v[110:111], v27 offset:8192
    s_waitcnt vmcnt(14)
    ds_read_b64_tr_b16 v[112:113], v24 offset:16384
    ds_read_b64_tr_b16 v[116:117], v25 offset:16384
    ds_read_b64_tr_b16 v[120:121], v26 offset:16384
    ds_read_b64_tr_b16 v[124:125], v27 offset:16384
    s_waitcnt vmcnt(12)
    ds_read_b64_tr_b16 v[114:115], v24 offset:24576
    ds_read_b64_tr_b16 v[118:119], v25 offset:24576
    ds_read_b64_tr_b16 v[122:123], v26 offset:24576
    ds_read_b64_tr_b16 v[126:127], v27 offset:24576
    s_waitcnt vmcnt(10)
    ds_read_b64_tr_b16 v[128:129], v24 offset:32768
    ds_read_b64_tr_b16 v[132:133], v25 offset:32768
    ds_read_b64_tr_b16 v[136:137], v26 offset:32768
    ds_read_b64_tr_b16 v[140:141], v27 offset:32768
    s_waitcnt vmcnt(8)
    ds_read_b64_tr_b16 v[130:131], v24 offset:40960
    ds_read_b64_tr_b16 v[134:135], v25 offset:40960
    ds_read_b64_tr_b16 v[138:139], v26 offset:40960
    ds_read_b64_tr_b16 v[142:143], v27 offset:40960
    s_mov_b32 s3, 0
L_bs0:
    ds_read_b32 v8, v3 offset:64388
    s_add_u32 s3, s3, 1
    s_waitcnt lgkmcnt(0)
    v_readfirstlane_b32 s8, v8
    s_cmp_gt_u32 s3, 3000000
    s_cbranch_scc1 L_bsx0
    s_cmp_lt_u32 s8, 4
    s_cbranch_scc1 L_bs0
L_bsx0:
    s_add_u32 m0, s76, 49152
    s_add_u32 s14, s36, 98304
    buffer_load_dwordx4 v10, s[56:59], s14 offen lds
    buffer_load_dwordx4 v11, s[56:59], s14 offen offset:1024 lds
    s_add_u32 m0, s76, 57344
    s_add_u32 s14, s36, 114688
    buffer_load_dwordx4 v10, s[56:59], s14 offen lds
    buffer_load_dwordx4 v11, s[56:59], s14 offen offset:1024 lds
    s_lshl2_add_u32 s12, s31, s6
    s_lshr_b32 s8, s4, 2
    s_lshl_b32 s8, s8, 5
    s_add_u32 s8, s8, s12
    s_lshl_b32 s8, s8, 7
    s_add_u32 s74, s8, 393216
    s_lshl_b32 s8, s12, 14
    s_lshr_b32 s13, s4, 1
    s_lshl_b32 s13, s13, 19
    s_add_u32 s8, s8, s13
    s_add_u32 s8, s8, 3145728
    s_and_b32 s13, s4, 1
    s_lshl2_add_u32 s13, s13, s30
    s_lshl_b32 s13, s13, 7
    v_lshrrev_b32 v8, 3, v1
    v_bfe_u32 v9, v1, 2, 1
    v_and_b32 v4, 3, v1
    v_lshl_add_u32 v16, v9, 6, s13
    v_lshl_add_u32 v16, v4, 4, v16
    v_lshlrev_b32 v17, 7, v8
    v_xor_b32 v16, v16, v17
    v_lshl_add_u32 v16, v8, 10, v16
    v_add_u32 v16, s8, v16
    v_lshl_add_u32 v4, v4, 1, v9
    v_and_b32 v9, 6, v8
    v_xor_b32 v4, v4, v9
    v_add_u32 v17, s76, v17
    v_lshl_add_u32 v18, v4, 4, v17
    v_add_u32 v17, 8192, v16
    s_lshl2_add_u32 s10, s4, s30
    s_lshl2_add_u32 s10, s10, s6
    s_lshl_b32 s8, s10, 7
    s_add_u32 s72, s8, 262144
    s_add_u32 s75, s8, 20480
    s_lshl_b32 s8, s10, 6
    s_add_u32 s8, s8, 73728
    v_and_b32 v8, 15, v1
    v_lshl_add_u32 v19, v8, 2, s8
    s_lshl_b32 s8, s6, 5
    v_xor_b32 v20, s8, v24
    s_lshl_b32 s8, s6, 11
    v_subrev_u32 v20, s8, v20
    v_bfe_u32 v9, v1, 4, 1
    v_lshlrev_b32 v21, 10, v8
    v_lshl_add_u32 v21, v9, 5, v21
    v_lshrrev_b32 v9, 5, v1
    v_lshl_add_u32 v21, v9, 4, v21
    s_lshl_b32 s70, s10, 14
    s_lshl_b32 s13, s31, 7
    s_add_u32 s70, s70, s13
    v_add_u32 v28, s76, v7
    v_xor_b32 v29, 0x800, v28
    v_xor_b32 v30, 0x1000, v28
    v_xor_b32 v31, 0x1800, v28
    s_mov_b32 s3, 0
L_bs1:
    ds_read_b32 v8, v3 offset:64392
    s_add_u32 s3, s3, 1
    s_waitcnt lgkmcnt(0)
    v_readfirstlane_b32 s8, v8
    s_cmp_gt_u32 s3, 3000000
    s_cbranch_scc1 L_bsx1
    s_cmp_lt_u32 s8, 1
    s_cbranch_scc1 L_bs1
L_bsx1:
    s_mov_b32 s7, s8
    s_mov_b32 s68, s8
    s_mov_b32 s69, s8
    s_add_u32 m0, s76, 65536
    s_add_u32 s14, s36, 131072
    buffer_load_dwordx4 v10, s[56:59], s14 offen lds
    buffer_load_dwordx4 v11, s[56:59], s14 offen offset:1024 lds
    s_add_u32 m0, s76, 73728
    s_add_u32 s14, s36, 147456
    buffer_load_dwordx4 v10, s[56:59], s14 offen lds
    buffer_load_dwordx4 v11, s[56:59], s14 offen offset:1024 lds
    s_add_u32 m0, s76, 81920
    s_add_u32 s14, s36, 163840
    buffer_load_dwordx4 v10, s[56:59], s14 offen lds
    buffer_load_dwordx4 v11, s[56:59], s14 offen offset:1024 lds
    s_waitcnt vmcnt(10)
    s_atomic_swap s7, s[46:47], s34
    s_branch L_join
L_spare:
    s_setprio 2
    v_mov_b32 v3, 0
    v_lshlrev_b32 v7, 4, v1
    s_mov_b32 s66, 12582912
    s_mov_b32 s67, 0x00020000
    s_mov_b64 s[64:65], s[46:47]
    s_lshl_b32 s76, s6, 11
    s_add_u32 s76, s76, 65536
    s_mov_b32 s58, 1835008
    s_mov_b32 s59, 0x00020000
    s_mov_b32 s62, 2097152
    s_mov_b32 s63, 0x00020000
    s_mov_b64 s[56:57], s[38:39]
    s_mov_b64 s[60:61], s[42:43]
    s_load_dword s16, s[46:47], 128
    s_sub_u32 s8, s5, 28
    s_lshl_b32 s9, s4, 2
    s_add_u32 s71, s8, s9
    s_lshl_b32 s8, s71, 2
    s_add_u32 s70, s8, s6
    s_lshl_b32 s72, s70, 11
    s_add_u32 s72, s72, 1048576
    v_lshrrev_b32 v9, 5, v1
    v_and_b32 v8, 31, v1
    v_lshlrev_b32 v15, 4, v8
    v_lshl_add_u32 v13, v9, 13, v15
    s_lshl_b32 s8, s70, 14
    s_add_u32 s9, s8, 4096
    buffer_load_dwordx4 v[32:35], v13, s[48:51], s8 offen offset:0
    buffer_load_dwordx4 v[36:39], v13, s[48:51], s8 offen offset:1024
    buffer_load_dwordx4 v[40:43], v13, s[48:51], s8 offen offset:2048
    buffer_load_dwordx4 v[44:47], v13, s[48:51], s8 offen offset:3072
    s_barrier
    buffer_load_dwordx4 v[48:51], v13, s[48:51], s9 offen offset:0
    buffer_load_dwordx4 v[52:55], v13, s[48:51], s9 offen offset:1024
    buffer_load_dwordx4 v[56:59], v13, s[48:51], s9 offen offset:2048
    buffer_load_dwordx4 v[60:63], v13, s[48:51], s9 offen offset:3072
    s_lshl_b32 s3, s2, 2
    s_add_u32 s3, s3, s6
    s_cmp_lg_u32 s3, 1023
    s_cbranch_scc1 L_nomaster
    s_memrealtime s[10:11]
    s_waitcnt lgkmcnt(0)
    s_max_u32 s3, s10, 1
    v_mov_b32 v8, s3
    s_mov_b64 exec, 1
    global_store_dword v3, v8, s[44:45] sc1
    s_mov_b64 exec, -1
L_nomaster:
    v_and_b32 v8, 1, v1
    v_lshlrev_b32 v8, 21, v8
    buffer_load_dword v6, v8, s[64:67], 0 offen offset:128
    buffer_load_dwordx4 v[64:67], v13, s[48:51], s8 offen offset:512
    buffer_load_dwordx4 v[68:71], v13, s[48:51], s8 offen offset:1536
    buffer_load_dwordx4 v[72:75], v13, s[48:51], s8 offen offset:2560
    buffer_load_dwordx4 v[76:79], v13, s[48:51], s8 offen offset:3584
    buffer_load_dwordx4 v[80:83], v13, s[48:51], s9 offen offset:512
    buffer_load_dwordx4 v[84:87], v13, s[48:51], s9 offen offset:1536
    buffer_load_dwordx4 v[88:91], v13, s[48:51], s9 offen offset:2560
    buffer_load_dwordx4 v[92:95], v13, s[48:51], s9 offen offset:3584
    global_load_dwordx4 v[96:99], v15, s[40:41]
    global_load_dwordx4 v[148:151], v15, s[40:41] offset:512
    s_mov_b32 s12, 0x05040100
    s_mov_b32 s13, 0x07060302
    v_bfe_u32 v8, v1, 2, 3
    s_and_b32 s8, s70, 7
    v_xor_b32 v8, s8, v8
    v_lshl_add_u32 v8, v8, 1, v9
    v_and_b32 v9, 3, v1
    v_lshl_add_u32 v8, v8, 2, v9
    v_lshlrev_b32 v14, 4, v8
    s_waitcnt vmcnt(11)
    v_perm_b32 v100, v36, v32, s12
    v_perm_b32 v101, v44, v40, s12
    v_perm_b32 v102, v52, v48, s12
    v_perm_b32 v103, v60, v56, s12
    s_add_u32 s8, s72, 0
    buffer_store_dwordx4 v[100:103], v14, s[64:67], s8 offen offset:0 sc1
    v_perm_b32 v104, v36, v32, s13
    v_perm_b32 v105, v44, v40, s13
    v_perm_b32 v106, v52, v48, s13
    v_perm_b32 v107, v60, v56, s13
    s_add_u32 s8, s72, 262144
    buffer_store_dwordx4 v[104:107], v14, s[64:67], s8 offen offset:0 sc1
    v_perm_b32 v108, v37, v33, s12
    v_perm_b32 v109, v45, v41, s12
    v_perm_b32 v110, v53, v49, s12
    v_perm_b32 v111, v61, v57, s12
    s_add_u32 s8, s72, 524288
    buffer_store_dwordx4 v[108:111], v14, s[64:67], s8 offen offset:0 sc1
    v_perm_b32 v112, v37, v33, s13
    v_perm_b32 v113, v45, v41, s13
    v_perm_b32 v114, v53, v49, s13
    v_perm_b32 v115, v61, v57, s13
    s_add_u32 s8, s72, 786432
    buffer_store_dwordx4 v[112:115], v14, s[64:67], s8 offen offset:0 sc1
    v_perm_b32 v116, v38, v34, s12
    v_perm_b32 v117, v46, v42, s12
    v_perm_b32 v118, v54, v50, s12
    v_perm_b32 v119, v62, v58, s12
    s_add_u32 s8, s72, 1048576
    buffer_store_dwordx4 v[116:119], v14, s[64:67], s8 offen offset:0 sc1
    v_perm_b32 v120, v38, v34, s13
    v_perm_b32 v121, v46, v42, s13
    v_perm_b32 v122, v54, v50, s13
    v_perm_b32 v123, v62, v58, s13
    s_add_u32 s8, s72, 1310720
    buffer_store_dwordx4 v[120:123], v14, s[64:67], s8 offen offset:0 sc1
    v_perm_b32 v124, v39, v35, s12
    v_perm_b32 v125, v47, v43, s12
    v_perm_b32 v126, v55, v51, s12
    v_perm_b32 v127, v63, v59, s12
    s_add_u32 s8, s72, 1572864
    buffer_store_dwordx4 v[124:127], v14, s[64:67], s8 offen offset:0 sc1
    v_perm_b32 v128, v39, v35, s13
    v_perm_b32 v129, v47, v43, s13
    v_perm_b32 v130, v55, v51, s13
    v_perm_b32 v131, v63, v59, s13
    s_add_u32 s8, s72, 1835008
    buffer_store_dwordx4 v[128:131], v14, s[64:67], s8 offen offset:0 sc1
    s_waitcnt vmcnt(10)
    global_load_dword v2, v3, s[44:45] sc1
    v_perm_b32 v100, v68, v64, s12
    v_perm_b32 v101, v76, v72, s12
    v_perm_b32 v102, v84, v80, s12
    v_perm_b32 v103, v92, v88, s12
    s_add_u32 s8, s72, 0
    buffer_store_dwordx4 v[100:103], v14, s[64:67], s8 offen offset:1024 sc1
    v_perm_b32 v104, v68, v64, s13
    v_perm_b32 v105, v76, v72, s13
    v_perm_b32 v106, v84, v80, s13
    v_perm_b32 v107, v92, v88, s13
    s_add_u32 s8, s72, 262144
    buffer_store_dwordx4 v[104:107], v14, s[64:67], s8 offen offset:1024 sc1
    v_perm_b32 v108, v69, v65, s12
    v_perm_b32 v109, v77, v73, s12
    v_perm_b32 v110, v85, v81, s12
    v_perm_b32 v111, v93, v89, s12
    s_add_u32 s8, s72, 524288
    buffer_store_dwordx4 v[108:111], v14, s[64:67], s8 offen offset:1024 sc1
    v_perm_b32 v112, v69, v65, s13
    v_perm_b32 v113, v77, v73, s13
    v_perm_b32 v114, v85, v81, s13
    v_perm_b32 v115, v93, v89, s13
    s_add_u32 s8, s72, 786432
    buffer_store_dwordx4 v[112:115], v14, s[64:67], s8 offen offset:1024 sc1
    v_perm_b32 v116, v70, v66, s12
    v_perm_b32 v117, v78, v74, s12
    v_perm_b32 v118, v86, v82, s12
    v_perm_b32 v119, v94, v90, s12
    s_add_u32 s8, s72, 1048576
    buffer_store_dwordx4 v[116:119], v14, s[64:67], s8 offen offset:1024 sc1
    v_perm_b32 v120, v70, v66, s13
    v_perm_b32 v121, v78, v74, s13
    v_perm_b32 v122, v86, v82, s13
    v_perm_b32 v123, v94, v90, s13
    s_add_u32 s8, s72, 1310720
    buffer_store_dwordx4 v[120:123], v14, s[64:67], s8 offen offset:1024 sc1
    v_perm_b32 v124, v71, v67, s12
    v_perm_b32 v125, v79, v75, s12
    v_perm_b32 v126, v87, v83, s12
    v_perm_b32 v127, v95, v91, s12
    s_add_u32 s8, s72, 1572864
    buffer_store_dwordx4 v[124:127], v14, s[64:67], s8 offen offset:1024 sc1
    v_perm_b32 v128, v71, v67, s13
    v_perm_b32 v129, v79, v75, s13
    v_perm_b32 v130, v87, v83, s13
    v_perm_b32 v131, v95, v91, s13
    s_add_u32 s8, s72, 1835008
    buffer_store_dwordx4 v[128:131], v14, s[64:67], s8 offen offset:1024 sc1
    s_waitcnt vmcnt(17)
    v_dot2_f32_bf16 v132, v32, v96, 0
    v_dot2_f32_bf16 v133, v36, v96, 0
    v_dot2_f32_bf16 v134, v40, v96, 0
    v_dot2_f32_bf16 v135, v44, v96, 0
    v_dot2_f32_bf16 v136, v48, v96, 0
    v_dot2_f32_bf16 v137, v52, v96, 0
    v_dot2_f32_bf16 v138, v56, v96, 0
    v_dot2_f32_bf16 v139, v60, v96, 0
    v_dot2_f32_bf16 v132, v33, v97, v132
    v_dot2_f32_bf16 v133, v37, v97, v133
    v_dot2_f32_bf16 v134, v41, v97, v134
    v_dot2_f32_bf16 v135, v45, v97, v135
    v_dot2_f32_bf16 v136, v49, v97, v136
    v_dot2_f32_bf16 v137, v53, v97, v137
    v_dot2_f32_bf16 v138, v57, v97, v138
    v_dot2_f32_bf16 v139, v61, v97, v139
    v_dot2_f32_bf16 v132, v34, v98, v132
    v_dot2_f32_bf16 v133, v38, v98, v133
    v_dot2_f32_bf16 v134, v42, v98, v134
    v_dot2_f32_bf16 v135, v46, v98, v135
    v_dot2_f32_bf16 v136, v50, v98, v136
    v_dot2_f32_bf16 v137, v54, v98, v137
    v_dot2_f32_bf16 v138, v58, v98, v138
    v_dot2_f32_bf16 v139, v62, v98, v139
    v_dot2_f32_bf16 v132, v35, v99, v132
    v_dot2_f32_bf16 v133, v39, v99, v133
    v_dot2_f32_bf16 v134, v43, v99, v134
    v_dot2_f32_bf16 v135, v47, v99, v135
    v_dot2_f32_bf16 v136, v51, v99, v136
    v_dot2_f32_bf16 v137, v55, v99, v137
    v_dot2_f32_bf16 v138, v59, v99, v138
    v_dot2_f32_bf16 v139, v63, v99, v139
    v_dot2_f32_bf16 v132, v64, v148, v132
    v_dot2_f32_bf16 v133, v68, v148, v133
    v_dot2_f32_bf16 v134, v72, v148, v134
    v_dot2_f32_bf16 v135, v76, v148, v135
    v_dot2_f32_bf16 v136, v80, v148, v136
    v_dot2_f32_bf16 v137, v84, v148, v137
    v_dot2_f32_bf16 v138, v88, v148, v138
    v_dot2_f32_bf16 v139, v92, v148, v139
    v_dot2_f32_bf16 v132, v65, v149, v132
    v_dot2_f32_bf16 v133, v69, v149, v133
    v_dot2_f32_bf16 v134, v73, v149, v134
    v_dot2_f32_bf16 v135, v77, v149, v135
    v_dot2_f32_bf16 v136, v81, v149, v136
    v_dot2_f32_bf16 v137, v85, v149, v137
    v_dot2_f32_bf16 v138, v89, v149, v138
    v_dot2_f32_bf16 v139, v93, v149, v139
    v_dot2_f32_bf16 v132, v66, v150, v132
    v_dot2_f32_bf16 v133, v70, v150, v133
    v_dot2_f32_bf16 v134, v74, v150, v134
    v_dot2_f32_bf16 v135, v78, v150, v135
    v_dot2_f32_bf16 v136, v82, v150, v136
    v_dot2_f32_bf16 v137, v86, v150, v137
    v_dot2_f32_bf16 v138, v90, v150, v138
    v_dot2_f32_bf16 v139, v94, v150, v139
    v_dot2_f32_bf16 v132, v67, v151, v132
    v_dot2_f32_bf16 v133, v71, v151, v133
    v_dot2_f32_bf16 v134, v75, v151, v134
    v_dot2_f32_bf16 v135, v79, v151, v135
    v_dot2_f32_bf16 v136, v83, v151, v136
    v_dot2_f32_bf16 v137, v87, v151, v137
    v_dot2_f32_bf16 v138, v91, v151, v138
    v_dot2_f32_bf16 v139, v95, v151, v139
    v_permlane16_swap_b32 v132, v133
    v_permlane16_swap_b32 v134, v135
    v_permlane16_swap_b32 v136, v137
    v_permlane16_swap_b32 v138, v139
    v_add_f32 v132, v132, v133
    v_add_f32 v134, v134, v135
    v_add_f32 v136, v136, v137
    v_add_f32 v138, v138, v139
    v_add_f32_dpp v132, v132, v132 row_ror:8 row_mask:0xf bank_mask:0xf
    v_add_f32_dpp v134, v134, v134 row_ror:8 row_mask:0xf bank_mask:0xf
    v_add_f32_dpp v136, v136, v136 row_ror:8 row_mask:0xf bank_mask:0xf
    v_add_f32_dpp v138, v138, v138 row_ror:8 row_mask:0xf bank_mask:0xf
    v_add_f32_dpp v132, v132, v132 row_ror:4 row_mask:0xf bank_mask:0xf
    v_add_f32_dpp v134, v134, v134 row_ror:4 row_mask:0xf bank_mask:0xf
    v_add_f32_dpp v136, v136, v136 row_ror:4 row_mask:0xf bank_mask:0xf
    v_add_f32_dpp v138, v138, v138 row_ror:4 row_mask:0xf bank_mask:0xf
    v_add_f32_dpp v132, v132, v132 row_ror:2 row_mask:0xf bank_mask:0xf
    v_add_f32_dpp v134, v134, v134 row_ror:2 row_mask:0xf bank_mask:0xf
    v_add_f32_dpp v136, v136, v136 row_ror:2 row_mask:0xf bank_mask:0xf
    v_add_f32_dpp v138, v138, v138 row_ror:2 row_mask:0xf bank_mask:0xf
    v_add_f32_dpp v132, v132, v132 row_ror:1 row_mask:0xf bank_mask:0xf
    v_add_f32_dpp v134, v134, v134 row_ror:1 row_mask:0xf bank_mask:0xf
    v_add_f32_dpp v136, v136, v136 row_ror:1 row_mask:0xf bank_mask:0xf
    v_add_f32_dpp v138, v138, v138 row_ror:1 row_mask:0xf bank_mask:0xf
    v_and_b32 v8, 3, v1
    v_cmp_eq_u32 vcc, 1, v8
    s_nop 1
    v_cndmask_b32 v132, v132, v134, vcc
    v_cmp_eq_u32 vcc, 2, v8
    s_nop 1
    v_cndmask_b32 v132, v132, v136, vcc
    v_cmp_eq_u32 vcc, 3, v8
    s_nop 1
    v_cndmask_b32 v132, v132, v138, vcc
    v_mul_f32 v132, 0xbfb8aa3b, v132
    v_exp_f32 v132, v132
    v_lshrrev_b32 v9, 5, v1
    v_lshl_add_u32 v9, v9, 2, v8
    v_add_f32 v132, 1.0, v132
    v_rcp_f32 v132, v132
    v_bfe_u32 v8, v1, 4, 1
    v_lshl_add_u32 v9, v9, 1, v8
    v_lshlrev_b32 v9, 2, v9
    s_lshl_b32 s9, s70, 6
    s_add_u32 s9, s9, 73728
    s_waitcnt vmcnt(8)
    v_readfirstlane_b32 s7, v2
    s_mov_b32 s3, 0
    s_waitcnt lgkmcnt(0)
L_ep2:
    s_cmp_lg_u32 s7, 0
    s_cbranch_scc1 L_epx2
    s_add_u32 s3, s3, 1
    s_cmp_gt_u32 s3, 40000
    s_cbranch_scc1 L_epx2
    s_sleep 2
    global_load_dword v2, v3, s[44:45] sc1
    s_waitcnt vmcnt(0)
    v_readfirstlane_b32 s7, v2
    s_nop 1
    s_branch L_ep2
L_epx2:
    s_mov_b32 s68, s7
    s_mov_b32 s69, s7
    v_mov_b32 v2, s7
    s_lshl_b32 s10, s71, 7
    s_add_u32 s10, s10, 4096
    v_mov_b32 v10, 1
    s_waitcnt vmcnt(0)
    s_mov_b64 exec, 1
    ds_add_rtn_u32 v10, v3, v10 offset:64388
    s_mov_b64 exec, -1
    s_waitcnt lgkmcnt(0)
    v_readfirstlane_b32 s8, v10
    s_nop 1
    s_cmp_eq_u32 s8, 3
    s_cbranch_scc0 L_ntp
    s_atomic_swap s7, s[46:47], s10
L_ntp:
    s_mov_b32 exec_lo, 0x000f000f
    s_mov_b32 exec_hi, 0x000f000f
    buffer_store_dword v132, v9, s[64:67], s9 offen sc1
    s_mov_b64 exec, -1
    s_setprio 0
    s_lshl_b32 s9, s70, 7
    s_add_u32 s9, s9, 20480
    s_waitcnt vmcnt(0)
    s_atomic_swap s7, s[46:47], s9
    s_setprio 0
    v_lshrrev_b32 v8, 3, v1
    v_lshlrev_b32 v8, 10, v8
    v_lshrrev_b32 v9, 4, v1
    v_lshlrev_b32 v9, 1, v9
    v_and_b32 v10, 7, v1
    v_xor_b32 v10, v10, v9
    v_lshl_add_u32 v10, v10, 4, v8
    v_add_u32 v11, 7168, v10
    s_cmp_ge_u32 s15, 3
    s_addc_u32 s8, s15, 0
    s_cmp_ge_u32 s5, 28
    s_cselect_b32 s31, 3, s8
    s_cselect_b32 s30, s15, s77
    s_mul_i32 s12, s6, 458752
    s_lshl_b32 s10, s31, 7
    s_add_u32 s12, s12, s10
    s_and_b32 s10, s4, 6
    s_lshr_b32 s11, s6, 1
    s_add_u32 s10, s10, s11
    s_and_b32 s11, s4, 1
    s_lshl1_add_u32 s10, s10, s11
    s_lshl2_add_u32 s10, s10, s30
    s_mul_i32 s10, s10, 112
    s_and_b32 s11, s6, 1
    s_mul_i32 s3, s11, 14
    s_add_u32 s10, s10, s3
    s_lshl_b32 s10, s10, 10
    s_add_u32 s13, s10, 5242880
    s_xor_b32 s3, s6, 0
    s_mul_i32 s3, s3, 28672
    v_add_u32 v12, s3, v7
    s_xor_b32 s3, s6, 1
    s_mul_i32 s3, s3, 28672
    v_add_u32 v13, s3, v7
    s_xor_b32 s3, s6, 2
    s_mul_i32 s3, s3, 28672
    v_add_u32 v14, s3, v7
    s_xor_b32 s3, s6, 3
    s_mul_i32 s3, s3, 28672
    v_add_u32 v15, s3, v7
    s_mov_b32 s10, 0
    s_add_u32 s11, s10, 0
    s_and_b32 s11, s11, 1
    s_mul_i32 s3, s11, 229376
    s_add_u32 s36, s12, s3
    s_mul_i32 s3, s11, 7168
    s_add_u32 s40, s13, s3
    s_add_u32 s11, s10, 1
    s_and_b32 s11, s11, 1
    s_mul_i32 s3, s11, 229376
    s_add_u32 s37, s12, s3
    s_mul_i32 s3, s11, 7168
    s_add_u32 s41, s13, s3
    v_lshrrev_b32 v8, 2, v1
    v_lshl_add_u32 v9, v8, 7, s76
    v_bfe_u32 v8, v1, 3, 2
    v_lshl_add_u32 v9, v8, 5, v9
    v_and_b32 v8, 3, v1
    v_lshl_add_u32 v24, v8, 3, v9
    v_xor_b32 v25, 32, v24
    v_xor_b32 v26, 64, v24
    v_xor_b32 v27, 96, v24
    v_add_u32 v2, 0x10000, v24
    v_xor_b32 v5, 32, v2
    v_xor_b32 v22, 64, v2
    v_xor_b32 v23, 96, v2
    s_lshl_b32 s8, s30, 15
    s_add_u32 s8, s8, s37
    s_add_u32 s8, s8, 98304
    buffer_load_dwordx4 v[32:35], v10, s[56:59], s8 offen
    s_add_u32 s8, s8, 8192
    buffer_load_dwordx4 v[36:39], v10, s[56:59], s8 offen
    s_add_u32 s8, s8, 8192
    buffer_load_dwordx4 v[40:43], v10, s[56:59], s8 offen
    s_add_u32 s8, s8, 8192
    buffer_load_dwordx4 v[44:47], v10, s[56:59], s8 offen
    s_add_u32 s8, s8, 8192
    s_add_u32 m0, s76, 0
    s_add_u32 s14, s36, 0
    buffer_load_dwordx4 v10, s[56:59], s14 offen lds
    buffer_load_dwordx4 v11, s[56:59], s14 offen offset:1024 lds
    s_add_u32 m0, s76, 8192
    s_add_u32 s14, s36, 16384
    buffer_load_dwordx4 v10, s[56:59], s14 offen lds
    buffer_load_dwordx4 v11, s[56:59], s14 offen offset:1024 lds
    s_add_u32 m0, s76, 16384
    s_add_u32 s14, s36, 32768
    buffer_load_dwordx4 v10, s[56:59], s14 offen lds
    buffer_load_dwordx4 v11, s[56:59], s14 offen offset:1024 lds
    s_add_u32 m0, s76, 24576
    s_add_u32 s14, s36, 49152
    buffer_load_dwordx4 v10, s[56:59], s14 offen lds
    buffer_load_dwordx4 v11, s[56:59], s14 offen offset:1024 lds
    s_add_u32 m0, s76, 32768
    s_add_u32 s14, s36, 65536
    buffer_load_dwordx4 v10, s[56:59], s14 offen lds
    buffer_load_dwordx4 v11, s[56:59], s14 offen offset:1024 lds
    s_add_u32 m0, s76, 40960
    s_add_u32 s14, s36, 81920
    buffer_load_dwordx4 v10, s[56:59], s14 offen lds
    buffer_load_dwordx4 v11, s[56:59], s14 offen offset:1024 lds
    s_waitcnt vmcnt(10)
    ds_read_b64_tr_b16 v[96:97], v24 offset:0
    ds_read_b64_tr_b16 v[100:101], v25 offset:0
    ds_read_b64_tr_b16 v[104:105], v26 offset:0
    ds_read_b64_tr_b16 v[108:109], v27 offset:0
    s_add_u32 m0, s76, 49152
    s_add_u32 s14, s36, 98304
    buffer_load_dwordx4 v10, s[56:59], s14 offen lds
    buffer_load_dwordx4 v11, s[56:59], s14 offen offset:1024 lds
    s_waitcnt vmcnt(10)
    ds_read_b64_tr_b16 v[98:99], v24 offset:8192
    ds_read_b64_tr_b16 v[102:103], v25 offset:8192
    ds_read_b64_tr_b16 v[106:107], v26 offset:8192
    ds_read_b64_tr_b16 v[110:111], v27 offset:8192
    s_add_u32 m0, s76, 57344
    s_add_u32 s14, s36, 114688
    buffer_load_dwordx4 v10, s[56:59], s14 offen lds
    buffer_load_dwordx4 v11, s[56:59], s14 offen offset:1024 lds
    s_waitcnt vmcnt(10)
    ds_read_b64_tr_b16 v[112:113], v24 offset:16384
    ds_read_b64_tr_b16 v[116:117], v25 offset:16384
    ds_read_b64_tr_b16 v[120:121], v26 offset:16384
    ds_read_b64_tr_b16 v[124:125], v27 offset:16384
    s_add_u32 m0, s76, 65536
    s_add_u32 s14, s36, 131072
    buffer_load_dwordx4 v10, s[56:59], s14 offen lds
    buffer_load_dwordx4 v11, s[56:59], s14 offen offset:1024 lds
    s_waitcnt vmcnt(10)
    ds_read_b64_tr_b16 v[114:115], v24 offset:24576
    ds_read_b64_tr_b16 v[118:119], v25 offset:24576
    ds_read_b64_tr_b16 v[122:123], v26 offset:24576
    ds_read_b64_tr_b16 v[126:127], v27 offset:24576
    s_add_u32 m0, s76, 73728
    s_add_u32 s14, s36, 147456
    buffer_load_dwordx4 v10, s[56:59], s14 offen lds
    buffer_load_dwordx4 v11, s[56:59], s14 offen offset:1024 lds
    s_waitcnt vmcnt(10)
    ds_read_b64_tr_b16 v[128:129], v24 offset:32768
    ds_read_b64_tr_b16 v[132:133], v25 offset:32768
    ds_read_b64_tr_b16 v[136:137], v26 offset:32768
    ds_read_b64_tr_b16 v[140:141], v27 offset:32768
    s_add_u32 m0, s76, 81920
    s_add_u32 s14, s36, 163840
    buffer_load_dwordx4 v10, s[56:59], s14 offen lds
    buffer_load_dwordx4 v11, s[56:59], s14 offen offset:1024 lds
    s_waitcnt vmcnt(10)
    ds_read_b64_tr_b16 v[130:131], v24 offset:40960
    ds_read_b64_tr_b16 v[134:135], v25 offset:40960
    ds_read_b64_tr_b16 v[138:139], v26 offset:40960
    ds_read_b64_tr_b16 v[142:143], v27 offset:40960
    s_lshl2_add_u32 s12, s31, s6
    s_lshr_b32 s8, s4, 2
    s_lshl_b32 s8, s8, 5
    s_add_u32 s8, s8, s12
    s_lshl_b32 s8, s8, 7
    s_add_u32 s74, s8, 393216
    s_lshl_b32 s8, s12, 14
    s_lshr_b32 s13, s4, 1
    s_lshl_b32 s13, s13, 19
    s_add_u32 s8, s8, s13
    s_add_u32 s8, s8, 3145728
    s_and_b32 s13, s4, 1
    s_lshl2_add_u32 s13, s13, s30
    s_lshl_b32 s13, s13, 7
    v_lshrrev_b32 v8, 3, v1
    v_bfe_u32 v9, v1, 2, 1
    v_and_b32 v4, 3, v1
    v_lshl_add_u32 v16, v9, 6, s13
    v_lshl_add_u32 v16, v4, 4, v16
    v_lshlrev_b32 v17, 7, v8
    v_xor_b32 v16, v16, v17
    v_lshl_add_u32 v16, v8, 10, v16
    v_add_u32 v16, s8, v16
    v_lshl_add_u32 v4, v4, 1, v9
    v_and_b32 v9, 6, v8
    v_xor_b32 v4, v4, v9
    v_add_u32 v17, s76, v17
    v_lshl_add_u32 v18, v4, 4, v17
    v_add_u32 v17, 8192, v16
    s_lshl2_add_u32 s10, s4, s30
    s_lshl2_add_u32 s10, s10, s6
    s_lshl_b32 s8, s10, 7
    s_add_u32 s72, s8, 262144
    s_add_u32 s75, s8, 20480
    s_lshl_b32 s8, s10, 6
    s_add_u32 s8, s8, 73728
    v_and_b32 v8, 15, v1
    v_lshl_add_u32 v19, v8, 2, s8
    s_lshl_b32 s8, s6, 5
    v_xor_b32 v20, s8, v24
    s_lshl_b32 s8, s6, 11
    v_subrev_u32 v20, s8, v20
    v_bfe_u32 v9, v1, 4, 1
    v_lshlrev_b32 v21, 10, v8
    v_lshl_add_u32 v21, v9, 5, v21
    v_lshrrev_b32 v9, 5, v1
    v_lshl_add_u32 v21, v9, 4, v21
    s_lshl_b32 s70, s10, 14
    s_lshl_b32 s13, s31, 7
    s_add_u32 s70, s70, s13
    v_add_u32 v28, s76, v7
    v_xor_b32 v29, 0x800, v28
    v_xor_b32 v30, 0x1000, v28
    v_xor_b32 v31, 0x1800, v28
    s_waitcnt lgkmcnt(0)
L_join:
    s_waitcnt vmcnt(8)
    ds_read_b64_tr_b16 v[144:145], v24 offset:49152
    ds_read_b64_tr_b16 v[148:149], v25 offset:49152
    ds_read_b64_tr_b16 v[152:153], v26 offset:49152
    ds_read_b64_tr_b16 v[156:157], v27 offset:49152
    s_add_u32 m0, s76, 90112
    s_add_u32 s14, s36, 180224
    buffer_load_dwordx4 v10, s[56:59], s14 offen lds
    buffer_load_dwordx4 v11, s[56:59], s14 offen offset:1024 lds
    s_waitcnt vmcnt(8)
    ds_read_b64_tr_b16 v[146:147], v24 offset:57344
    ds_read_b64_tr_b16 v[150:151], v25 offset:57344
    ds_read_b64_tr_b16 v[154:155], v26 offset:57344
    ds_read_b64_tr_b16 v[158:159], v27 offset:57344
    s_waitcnt lgkmcnt(15)
    s_add_u32 m0, s76, 0
    s_add_u32 s14, s36, 196608
    buffer_load_dwordx4 v10, s[56:59], s14 offen lds
    buffer_load_dwordx4 v11, s[56:59], s14 offen offset:1024 lds
    s_waitcnt vmcnt(8)
    ds_read_b64_tr_b16 v[160:161], v2 offset:0
    ds_read_b64_tr_b16 v[164:165], v5 offset:0
    ds_read_b64_tr_b16 v[168:169], v22 offset:0
    ds_read_b64_tr_b16 v[172:173], v23 offset:0
    s_waitcnt lgkmcnt(15)
    s_add_u32 m0, s76, 8192
    s_add_u32 s14, s36, 212992
    buffer_load_dwordx4 v10, s[56:59], s14 offen lds
    buffer_load_dwordx4 v11, s[56:59], s14 offen offset:1024 lds
    s_waitcnt vmcnt(8)
    ds_read_b64_tr_b16 v[162:163], v2 offset:8192
    ds_read_b64_tr_b16 v[166:167], v5 offset:8192
    ds_read_b64_tr_b16 v[170:171], v22 offset:8192
    ds_read_b64_tr_b16 v[174:175], v23 offset:8192
    s_waitcnt lgkmcnt(15)
    s_add_u32 m0, s76, 16384
    s_add_u32 s14, s37, 0
    buffer_load_dwordx4 v10, s[56:59], s14 offen lds
    buffer_load_dwordx4 v11, s[56:59], s14 offen offset:1024 lds
    s_waitcnt vmcnt(8)
    ds_read_b64_tr_b16 v[176:177], v2 offset:16384
    ds_read_b64_tr_b16 v[180:181], v5 offset:16384
    ds_read_b64_tr_b16 v[184:185], v22 offset:16384
    ds_read_b64_tr_b16 v[188:189], v23 offset:16384
    s_waitcnt lgkmcnt(15)
    s_add_u32 m0, s76, 24576
    s_add_u32 s14, s37, 16384
    buffer_load_dwordx4 v10, s[56:59], s14 offen lds
    buffer_load_dwordx4 v11, s[56:59], s14 offen offset:1024 lds
    s_waitcnt vmcnt(8)
    ds_read_b64_tr_b16 v[178:179], v2 offset:24576
    ds_read_b64_tr_b16 v[182:183], v5 offset:24576
    ds_read_b64_tr_b16 v[186:187], v22 offset:24576
    ds_read_b64_tr_b16 v[190:191], v23 offset:24576
    s_waitcnt lgkmcnt(15)
    s_add_u32 m0, s76, 32768
    s_add_u32 s14, s37, 32768
    buffer_load_dwordx4 v10, s[56:59], s14 offen lds
    buffer_load_dwordx4 v11, s[56:59], s14 offen offset:1024 lds
    s_waitcnt lgkmcnt(15)
    s_add_u32 m0, s76, 40960
    s_add_u32 s14, s37, 49152
    buffer_load_dwordx4 v10, s[56:59], s14 offen lds
    buffer_load_dwordx4 v11, s[56:59], s14 offen offset:1024 lds
    s_waitcnt lgkmcnt(15)
    s_add_u32 m0, s76, 49152
    s_add_u32 s14, s37, 65536
    buffer_load_dwordx4 v10, s[56:59], s14 offen lds
    buffer_load_dwordx4 v11, s[56:59], s14 offen offset:1024 lds
    s_waitcnt lgkmcnt(15)
    s_add_u32 m0, s76, 57344
    s_add_u32 s14, s37, 81920
    buffer_load_dwordx4 v10, s[56:59], s14 offen lds
    buffer_load_dwordx4 v11, s[56:59], s14 offen offset:1024 lds
    s_waitcnt lgkmcnt(12)
    s_add_u32 m0, s76, 65536
    s_add_u32 s14, s37, 98304
    buffer_load_dwordx4 v10, s[56:59], s14 offen lds
    buffer_load_dwordx4 v11, s[56:59], s14 offen offset:1024 lds
    s_waitcnt lgkmcnt(0)
    s_load_dwordx8 s[16:23], s[46:47], s72 glc
    s_add_u32 m0, s76, 73728
    s_add_u32 s14, s37, 114688
    buffer_load_dwordx4 v10, s[56:59], s14 offen lds
    buffer_load_dwordx4 v11, s[56:59], s14 offen offset:1024 lds
    s_add_u32 m0, s76, 81920
    s_add_u32 s14, s37, 131072
    buffer_load_dwordx4 v10, s[56:59], s14 offen lds
    buffer_load_dwordx4 v11, s[56:59], s14 offen offset:1024 lds
    s_add_u32 m0, s76, 90112
    s_add_u32 s14, s37, 147456
    buffer_load_dwordx4 v10, s[56:59], s14 offen lds
    buffer_load_dwordx4 v11, s[56:59], s14 offen offset:1024 lds
    s_mov_b32 s3, 0
L_poll3:
    s_waitcnt lgkmcnt(0)
    s_mov_b32 s23, s22
    s_xor_b64 s[16:17], s[16:17], s[68:69]
    s_xor_b64 s[18:19], s[18:19], s[68:69]
    s_xor_b64 s[20:21], s[20:21], s[68:69]
    s_xor_b64 s[22:23], s[22:23], s[68:69]
    s_or_b64 s[16:17], s[16:17], s[18:19]
    s_or_b64 s[16:17], s[16:17], s[20:21]
    s_or_b64 s[16:17], s[16:17], s[22:23]
    s_cbranch_scc0 L_pollx3
    s_add_u32 s3, s3, 1
    s_cmp_gt_u32 s3, 40000
    s_cbranch_scc1 L_pollx3
    s_sleep 3
    s_load_dwordx8 s[16:23], s[46:47], s72 glc
    s_branch L_poll3
L_pollx3:
    s_setprio 0
    s_add_u32 s15, s40, 0
    buffer_load_dwordx4 v[44:47], v15, s[64:67], s15 offen sc1
    buffer_load_dwordx4 v[40:43], v14, s[64:67], s15 offen sc1
    buffer_load_dwordx4 v[36:39], v13, s[64:67], s15 offen sc1
    buffer_load_dwordx4 v[32:35], v12, s[64:67], s15 offen sc1
    s_add_u32 s15, s40, 1024
    buffer_load_dwordx4 v[60:63], v15, s[64:67], s15 offen sc1
    buffer_load_dwordx4 v[56:59], v14, s[64:67], s15 offen sc1
    buffer_load_dwordx4 v[52:55], v13, s[64:67], s15 offen sc1
    buffer_load_dwordx4 v[48:51], v12, s[64:67], s15 offen sc1
    s_add_u32 s15, s40, 2048
    buffer_load_dwordx4 v[76:79], v15, s[64:67], s15 offen sc1
    buffer_load_dwordx4 v[72:75], v14, s[64:67], s15 offen sc1
    buffer_load_dwordx4 v[68:71], v13, s[64:67], s15 offen sc1
    buffer_load_dwordx4 v[64:67], v12, s[64:67], s15 offen sc1
    s_waitcnt lgkmcnt(15)
    s_waitcnt vmcnt(11)
    v_mfma_f32_16x16x32_bf16 v[240:243], v[96:99], v[44:47], 0
    s_add_u32 s15, s40, 3072
    buffer_load_dwordx4 v[92:95], v15, s[64:67], s15 offen sc1
    v_mfma_f32_16x16x32_bf16 v[244:247], v[100:103], v[44:47], 0
    v_mfma_f32_16x16x32_bf16 v[248:251], v[104:107], v[44:47], 0
    v_mfma_f32_16x16x32_bf16 v[252:255], v[108:111], v[44:47], 0
    s_waitcnt vmcnt(11)
    v_mfma_f32_16x16x32_bf16 v[224:227], v[96:99], v[40:43], 0
    buffer_load_dwordx4 v[88:91], v14, s[64:67], s15 offen sc1
    v_mfma_f32_16x16x32_bf16 v[228:231], v[100:103], v[40:43], 0
    v_mfma_f32_16x16x32_bf16 v[232:235], v[104:107], v[40:43], 0
    v_mfma_f32_16x16x32_bf16 v[236:239], v[108:111], v[40:43], 0
    s_waitcnt vmcnt(11)
    v_mfma_f32_16x16x32_bf16 v[208:211], v[96:99], v[36:39], 0
    buffer_load_dwordx4 v[84:87], v13, s[64:67], s15 offen sc1
    v_mfma_f32_16x16x32_bf16 v[212:215], v[100:103], v[36:39], 0
    v_mfma_f32_16x16x32_bf16 v[216:219], v[104:107], v[36:39], 0
    v_mfma_f32_16x16x32_bf16 v[220:223], v[108:111], v[36:39], 0
    s_waitcnt vmcnt(11)
    v_mfma_f32_16x16x32_bf16 v[192:195], v[96:99], v[32:35], 0
    buffer_load_dwordx4 v[80:83], v12, s[64:67], s15 offen sc1
    v_mfma_f32_16x16x32_bf16 v[196:199], v[100:103], v[32:35], 0
    v_mfma_f32_16x16x32_bf16 v[200:203], v[104:107], v[32:35], 0
    v_mfma_f32_16x16x32_bf16 v[204:207], v[108:111], v[32:35], 0
    s_waitcnt lgkmcnt(15)
    s_waitcnt vmcnt(11)
    v_mfma_f32_16x16x32_bf16 v[240:243], v[112:115], v[60:63], v[240:243]
    s_add_u32 s15, s40, 4096
    buffer_load_dwordx4 v[44:47], v15, s[64:67], s15 offen sc1
    v_mfma_f32_16x16x32_bf16 v[244:247], v[116:119], v[60:63], v[244:247]
    s_waitcnt vmcnt(39)
    ds_read_b64_tr_b16 v[96:97], v24 offset:0
    v_mfma_f32_16x16x32_bf16 v[248:251], v[120:123], v[60:63], v[248:251]
    ds_read_b64_tr_b16 v[100:101], v25 offset:0
    ds_read_b64_tr_b16 v[104:105], v26 offset:0
    v_mfma_f32_16x16x32_bf16 v[252:255], v[124:127], v[60:63], v[252:255]
    ds_read_b64_tr_b16 v[108:109], v27 offset:0
    s_waitcnt lgkmcnt(0)
    s_waitcnt vmcnt(11)
    v_mfma_f32_16x16x32_bf16 v[224:227], v[112:115], v[56:59], v[224:227]
    buffer_load_dwordx4 v[40:43], v14, s[64:67], s15 offen sc1
    v_mfma_f32_16x16x32_bf16 v[228:231], v[116:119], v[56:59], v[228:231]
    s_add_u32 m0, s76, 0
    s_add_u32 s14, s37, 163840
    v_mfma_f32_16x16x32_bf16 v[232:235], v[120:123], v[56:59], v[232:235]
    buffer_load_dwordx4 v10, s[56:59], s14 offen lds
    buffer_load_dwordx4 v11, s[56:59], s14 offen offset:1024 lds
    v_mfma_f32_16x16x32_bf16 v[236:239], v[124:127], v[56:59], v[236:239]
    s_waitcnt vmcnt(40)
    ds_read_b64_tr_b16 v[98:99], v24 offset:8192
    s_waitcnt vmcnt(13)
    v_mfma_f32_16x16x32_bf16 v[208:211], v[112:115], v[52:55], v[208:211]
    buffer_load_dwordx4 v[36:39], v13, s[64:67], s15 offen sc1
    v_mfma_f32_16x16x32_bf16 v[212:215], v[116:119], v[52:55], v[212:215]
    ds_read_b64_tr_b16 v[102:103], v25 offset:8192
    ds_read_b64_tr_b16 v[106:107], v26 offset:8192
    v_mfma_f32_16x16x32_bf16 v[216:219], v[120:123], v[52:55], v[216:219]
    ds_read_b64_tr_b16 v[110:111], v27 offset:8192
    v_mfma_f32_16x16x32_bf16 v[220:223], v[124:127], v[52:55], v[220:223]
    s_waitcnt vmcnt(13)
    v_mfma_f32_16x16x32_bf16 v[192:195], v[112:115], v[48:51], v[192:195]
    buffer_load_dwordx4 v[32:35], v12, s[64:67], s15 offen sc1
    v_mfma_f32_16x16x32_bf16 v[196:199], v[116:119], v[48:51], v[196:199]
    v_mfma_f32_16x16x32_bf16 v[200:203], v[120:123], v[48:51], v[200:203]
    v_mfma_f32_16x16x32_bf16 v[204:207], v[124:127], v[48:51], v[204:207]
    s_waitcnt lgkmcnt(15)
    s_waitcnt vmcnt(13)
    v_mfma_f32_16x16x32_bf16 v[240:243], v[128:131], v[76:79], v[240:243]
    s_add_u32 s15, s40, 5120
    buffer_load_dwordx4 v[60:63], v15, s[64:67], s15 offen sc1
    v_mfma_f32_16x16x32_bf16 v[244:247], v[132:135], v[76:79], v[244:247]
    s_waitcnt lgkmcnt(0)
    s_add_u32 m0, s76, 8192
    v_mfma_f32_16x16x32_bf16 v[248:251], v[136:139], v[76:79], v[248:251]
    s_add_u32 s14, s37, 180224
    buffer_load_dwordx4 v10, s[56:59], s14 offen lds
    v_mfma_f32_16x16x32_bf16 v[252:255], v[140:143], v[76:79], v[252:255]
    buffer_load_dwordx4 v11, s[56:59], s14 offen offset:1024 lds
    s_waitcnt vmcnt(43)
    s_waitcnt vmcnt(15)
    v_mfma_f32_16x16x32_bf16 v[224:227], v[128:131], v[72:75], v[224:227]
    buffer_load_dwordx4 v[56:59], v14, s[64:67], s15 offen sc1
    v_mfma_f32_16x16x32_bf16 v[228:231], v[132:135], v[72:75], v[228:231]
    ds_read_b64_tr_b16 v[112:113], v24 offset:16384
    ds_read_b64_tr_b16 v[116:117], v25 offset:16384
    v_mfma_f32_16x16x32_bf16 v[232:235], v[136:139], v[72:75], v[232:235]
    ds_read_b64_tr_b16 v[120:121], v26 offset:16384
    ds_read_b64_tr_b16 v[124:125], v27 offset:16384
    v_mfma_f32_16x16x32_bf16 v[236:239], v[140:143], v[72:75], v[236:239]
    s_waitcnt lgkmcnt(0)
    s_add_u32 m0, s76, 16384
    s_waitcnt vmcnt(15)
    v_mfma_f32_16x16x32_bf16 v[208:211], v[128:131], v[68:71], v[208:211]
    buffer_load_dwordx4 v[52:55], v13, s[64:67], s15 offen sc1
    v_mfma_f32_16x16x32_bf16 v[212:215], v[132:135], v[68:71], v[212:215]
    s_add_u32 s14, s37, 196608
    buffer_load_dwordx4 v10, s[56:59], s14 offen lds
    v_mfma_f32_16x16x32_bf16 v[216:219], v[136:139], v[68:71], v[216:219]
    buffer_load_dwordx4 v11, s[56:59], s14 offen offset:1024 lds
    s_waitcnt vmcnt(45)
    v_mfma_f32_16x16x32_bf16 v[220:223], v[140:143], v[68:71], v[220:223]
    ds_read_b64_tr_b16 v[114:115], v24 offset:24576
    ds_read_b64_tr_b16 v[118:119], v25 offset:24576
    s_waitcnt vmcnt(17)
    v_mfma_f32_16x16x32_bf16 v[192:195], v[128:131], v[64:67], v[192:195]
    buffer_load_dwordx4 v[48:51], v12, s[64:67], s15 offen sc1
    v_mfma_f32_16x16x32_bf16 v[196:199], v[132:135], v[64:67], v[196:199]
    ds_read_b64_tr_b16 v[122:123], v26 offset:24576
    ds_read_b64_tr_b16 v[126:127], v27 offset:24576
    v_mfma_f32_16x16x32_bf16 v[200:203], v[136:139], v[64:67], v[200:203]
    v_mfma_f32_16x16x32_bf16 v[204:207], v[140:143], v[64:67], v[204:207]
    s_waitcnt lgkmcnt(15)
    s_waitcnt vmcnt(17)
    v_mfma_f32_16x16x32_bf16 v[240:243], v[144:147], v[92:95], v[240:243]
    s_add_u32 s15, s40, 6144
    buffer_load_dwordx4 v[76:79], v15, s[64:67], s15 offen sc1
    v_mfma_f32_16x16x32_bf16 v[244:247], v[148:151], v[92:95], v[244:247]
    s_waitcnt lgkmcnt(0)
    s_add_u32 m0, s76, 24576
    v_mfma_f32_16x16x32_bf16 v[248:251], v[152:155], v[92:95], v[248:251]
    s_add_u32 s14, s37, 212992
    buffer_load_dwordx4 v10, s[56:59], s14 offen lds
    v_mfma_f32_16x16x32_bf16 v[252:255], v[156:159], v[92:95], v[252:255]
    buffer_load_dwordx4 v11, s[56:59], s14 offen offset:1024 lds
    s_waitcnt vmcnt(47)
    s_waitcnt vmcnt(19)
    v_mfma_f32_16x16x32_bf16 v[224:227], v[144:147], v[88:91], v[224:227]
    buffer_load_dwordx4 v[72:75], v14, s[64:67], s15 offen sc1
    v_mfma_f32_16x16x32_bf16 v[228:231], v[148:151], v[88:91], v[228:231]
    ds_read_b64_tr_b16 v[128:129], v24 offset:32768
    ds_read_b64_tr_b16 v[132:133], v25 offset:32768
    v_mfma_f32_16x16x32_bf16 v[232:235], v[152:155], v[88:91], v[232:235]
    ds_read_b64_tr_b16 v[136:137], v26 offset:32768
    ds_read_b64_tr_b16 v[140:141], v27 offset:32768
    v_mfma_f32_16x16x32_bf16 v[236:239], v[156:159], v[88:91], v[236:239]
    s_waitcnt vmcnt(46)
    ds_read_b64_tr_b16 v[130:131], v24 offset:40960
    s_waitcnt vmcnt(19)
    v_mfma_f32_16x16x32_bf16 v[208:211], v[144:147], v[84:87], v[208:211]
    buffer_load_dwordx4 v[68:71], v13, s[64:67], s15 offen sc1
    v_mfma_f32_16x16x32_bf16 v[212:215], v[148:151], v[84:87], v[212:215]
    ds_read_b64_tr_b16 v[134:135], v25 offset:40960
    ds_read_b64_tr_b16 v[138:139], v26 offset:40960
    v_mfma_f32_16x16x32_bf16 v[216:219], v[152:155], v[84:87], v[216:219]
    ds_read_b64_tr_b16 v[142:143], v27 offset:40960
    v_mfma_f32_16x16x32_bf16 v[220:223], v[156:159], v[84:87], v[220:223]
    s_waitcnt vmcnt(19)
    v_mfma_f32_16x16x32_bf16 v[192:195], v[144:147], v[80:83], v[192:195]
    buffer_load_dwordx4 v[64:67], v12, s[64:67], s15 offen sc1
    v_mfma_f32_16x16x32_bf16 v[196:199], v[148:151], v[80:83], v[196:199]
    v_mfma_f32_16x16x32_bf16 v[200:203], v[152:155], v[80:83], v[200:203]
    v_mfma_f32_16x16x32_bf16 v[204:207], v[156:159], v[80:83], v[204:207]
    s_waitcnt lgkmcnt(15)
    s_waitcnt vmcnt(19)
    v_mfma_f32_16x16x32_bf16 v[240:243], v[160:163], v[44:47], v[240:243]
    s_add_u32 s15, s41, 0
    buffer_load_dwordx4 v[92:95], v15, s[64:67], s15 offen sc1
    v_mfma_f32_16x16x32_bf16 v[244:247], v[164:167], v[44:47], v[244:247]
    s_waitcnt vmcnt(47)
    ds_read_b64_tr_b16 v[144:145], v24 offset:49152
    v_mfma_f32_16x16x32_bf16 v[248:251], v[168:171], v[44:47], v[248:251]
    ds_read_b64_tr_b16 v[148:149], v25 offset:49152
    ds_read_b64_tr_b16 v[152:153], v26 offset:49152
    v_mfma_f32_16x16x32_bf16 v[252:255], v[172:175], v[44:47], v[252:255]
    ds_read_b64_tr_b16 v[156:157], v27 offset:49152
    s_waitcnt vmcnt(45)
    s_waitcnt vmcnt(19)
    v_mfma_f32_16x16x32_bf16 v[224:227], v[160:163], v[40:43], v[224:227]
    buffer_load_dwordx4 v[88:91], v14, s[64:67], s15 offen sc1
    v_mfma_f32_16x16x32_bf16 v[228:231], v[164:167], v[40:43], v[228:231]
    ds_read_b64_tr_b16 v[146:147], v24 offset:57344
    ds_read_b64_tr_b16 v[150:151], v25 offset:57344
    v_mfma_f32_16x16x32_bf16 v[232:235], v[168:171], v[40:43], v[232:235]
    ds_read_b64_tr_b16 v[154:155], v26 offset:57344
    ds_read_b64_tr_b16 v[158:159], v27 offset:57344
    v_mfma_f32_16x16x32_bf16 v[236:239], v[172:175], v[40:43], v[236:239]
    s_waitcnt vmcnt(17)
    v_mfma_f32_16x16x32_bf16 v[208:211], v[160:163], v[36:39], v[208:211]
    buffer_load_dwordx4 v[84:87], v13, s[64:67], s15 offen sc1
    v_mfma_f32_16x16x32_bf16 v[212:215], v[164:167], v[36:39], v[212:215]
    v_mfma_f32_16x16x32_bf16 v[216:219], v[168:171], v[36:39], v[216:219]
    v_mfma_f32_16x16x32_bf16 v[220:223], v[172:175], v[36:39], v[220:223]
    s_waitcnt vmcnt(17)
    v_mfma_f32_16x16x32_bf16 v[192:195], v[160:163], v[32:35], v[192:195]
    buffer_load_dwordx4 v[80:83], v12, s[64:67], s15 offen sc1
    v_mfma_f32_16x16x32_bf16 v[196:199], v[164:167], v[32:35], v[196:199]
    v_mfma_f32_16x16x32_bf16 v[200:203], v[168:171], v[32:35], v[200:203]
    v_mfma_f32_16x16x32_bf16 v[204:207], v[172:175], v[32:35], v[204:207]
    s_waitcnt lgkmcnt(15)
    s_waitcnt vmcnt(17)
    v_mfma_f32_16x16x32_bf16 v[240:243], v[176:179], v[60:63], v[240:243]
    s_add_u32 s15, s41, 1024
    buffer_load_dwordx4 v[44:47], v15, s[64:67], s15 offen sc1
    v_mfma_f32_16x16x32_bf16 v[244:247], v[180:183], v[60:63], v[244:247]
    s_waitcnt vmcnt(47)
    ds_read_b64_tr_b16 v[160:161], v2 offset:0
    v_mfma_f32_16x16x32_bf16 v[248:251], v[184:187], v[60:63], v[248:251]
    ds_read_b64_tr_b16 v[164:165], v5 offset:0
    ds_read_b64_tr_b16 v[168:169], v22 offset:0
    v_mfma_f32_16x16x32_bf16 v[252:255], v[188:191], v[60:63], v[252:255]
    ds_read_b64_tr_b16 v[172:173], v23 offset:0
    s_waitcnt vmcnt(45)
    s_waitcnt vmcnt(15)
    v_mfma_f32_16x16x32_bf16 v[224:227], v[176:179], v[56:59], v[224:227]
    buffer_load_dwordx4 v[40:43], v14, s[64:67], s15 offen sc1
    v_mfma_f32_16x16x32_bf16 v[228:231], v[180:183], v[56:59], v[228:231]
    ds_read_b64_tr_b16 v[162:163], v2 offset:8192
    ds_read_b64_tr_b16 v[166:167], v5 offset:8192
    v_mfma_f32_16x16x32_bf16 v[232:235], v[184:187], v[56:59], v[232:235]
    ds_read_b64_tr_b16 v[170:171], v22 offset:8192
    ds_read_b64_tr_b16 v[174:175], v23 offset:8192
    v_mfma_f32_16x16x32_bf16 v[236:239], v[188:191], v[56:59], v[236:239]
    s_waitcnt vmcnt(15)
    v_mfma_f32_16x16x32_bf16 v[208:211], v[176:179], v[52:55], v[208:211]
    buffer_load_dwordx4 v[36:39], v13, s[64:67], s15 offen sc1
    v_mfma_f32_16x16x32_bf16 v[212:215], v[180:183], v[52:55], v[212:215]
    v_mfma_f32_16x16x32_bf16 v[216:219], v[184:187], v[52:55], v[216:219]
    v_mfma_f32_16x16x32_bf16 v[220:223], v[188:191], v[52:55], v[220:223]
    s_waitcnt vmcnt(13)
    v_mfma_f32_16x16x32_bf16 v[192:195], v[176:179], v[48:51], v[192:195]
    buffer_load_dwordx4 v[32:35], v12, s[64:67], s15 offen sc1
    v_mfma_f32_16x16x32_bf16 v[196:199], v[180:183], v[48:51], v[196:199]
    v_mfma_f32_16x16x32_bf16 v[200:203], v[184:187], v[48:51], v[200:203]
    v_mfma_f32_16x16x32_bf16 v[204:207], v[188:191], v[48:51], v[204:207]
    s_waitcnt lgkmcnt(15)
    s_waitcnt vmcnt(13)
    v_mfma_f32_16x16x32_bf16 v[240:243], v[96:99], v[76:79], v[240:243]
    s_add_u32 s15, s41, 2048
    buffer_load_dwordx4 v[60:63], v15, s[64:67], s15 offen sc1
    v_mfma_f32_16x16x32_bf16 v[244:247], v[100:103], v[76:79], v[244:247]
    s_waitcnt vmcnt(47)
    ds_read_b64_tr_b16 v[176:177], v2 offset:16384
    v_mfma_f32_16x16x32_bf16 v[248:251], v[104:107], v[76:79], v[248:251]
    ds_read_b64_tr_b16 v[180:181], v5 offset:16384
    ds_read_b64_tr_b16 v[184:185], v22 offset:16384
    v_mfma_f32_16x16x32_bf16 v[252:255], v[108:111], v[76:79], v[252:255]
    ds_read_b64_tr_b16 v[188:189], v23 offset:16384
    s_waitcnt vmcnt(45)
    s_waitcnt vmcnt(11)
    v_mfma_f32_16x16x32_bf16 v[224:227], v[96:99], v[72:75], v[224:227]
    buffer_load_dwordx4 v[56:59], v14, s[64:67], s15 offen sc1
    v_mfma_f32_16x16x32_bf16 v[228:231], v[100:103], v[72:75], v[228:231]
    ds_read_b64_tr_b16 v[178:179], v2 offset:24576
    ds_read_b64_tr_b16 v[182:183], v5 offset:24576
    v_mfma_f32_16x16x32_bf16 v[232:235], v[104:107], v[72:75], v[232:235]
    ds_read_b64_tr_b16 v[186:187], v22 offset:24576
    ds_read_b64_tr_b16 v[190:191], v23 offset:24576
    v_mfma_f32_16x16x32_bf16 v[236:239], v[108:111], v[72:75], v[236:239]
    s_waitcnt vmcnt(11)
    v_mfma_f32_16x16x32_bf16 v[208:211], v[96:99], v[68:71], v[208:211]
    buffer_load_dwordx4 v[52:55], v13, s[64:67], s15 offen sc1
    v_mfma_f32_16x16x32_bf16 v[212:215], v[100:103], v[68:71], v[212:215]
    v_mfma_f32_16x16x32_bf16 v[216:219], v[104:107], v[68:71], v[216:219]
    v_mfma_f32_16x16x32_bf16 v[220:223], v[108:111], v[68:71], v[220:223]
    s_waitcnt vmcnt(11)
    v_mfma_f32_16x16x32_bf16 v[192:195], v[96:99], v[64:67], v[192:195]
    buffer_load_dwordx4 v[48:51], v12, s[64:67], s15 offen sc1
    v_mfma_f32_16x16x32_bf16 v[196:199], v[100:103], v[64:67], v[196:199]
    v_mfma_f32_16x16x32_bf16 v[200:203], v[104:107], v[64:67], v[200:203]
    v_mfma_f32_16x16x32_bf16 v[204:207], v[108:111], v[64:67], v[204:207]
    s_waitcnt lgkmcnt(15)
    s_waitcnt vmcnt(11)
    v_mfma_f32_16x16x32_bf16 v[240:243], v[112:115], v[92:95], v[240:243]
    s_add_u32 s15, s41, 3072
    buffer_load_dwordx4 v[76:79], v15, s[64:67], s15 offen sc1
    v_mfma_f32_16x16x32_bf16 v[244:247], v[116:119], v[92:95], v[244:247]
    s_waitcnt vmcnt(29)
    ds_read_b64_tr_b16 v[96:97], v24 offset:0
    v_mfma_f32_16x16x32_bf16 v[248:251], v[120:123], v[92:95], v[248:251]
    ds_read_b64_tr_b16 v[100:101], v25 offset:0
    ds_read_b64_tr_b16 v[104:105], v26 offset:0
    v_mfma_f32_16x16x32_bf16 v[252:255], v[124:127], v[92:95], v[252:255]
    ds_read_b64_tr_b16 v[108:109], v27 offset:0
    s_waitcnt vmcnt(24)
    s_waitcnt vmcnt(11)
    v_mfma_f32_16x16x32_bf16 v[224:227], v[112:115], v[88:91], v[224:227]
    buffer_load_dwordx4 v[72:75], v14, s[64:67], s15 offen sc1
    v_mfma_f32_16x16x32_bf16 v[228:231], v[116:119], v[88:91], v[228:231]
    ds_read_b64_tr_b16 v[98:99], v24 offset:8192
    ds_read_b64_tr_b16 v[102:103], v25 offset:8192
    v_mfma_f32_16x16x32_bf16 v[232:235], v[120:123], v[88:91], v[232:235]
    ds_read_b64_tr_b16 v[106:107], v26 offset:8192
    ds_read_b64_tr_b16 v[110:111], v27 offset:8192
    v_mfma_f32_16x16x32_bf16 v[236:239], v[124:127], v[88:91], v[236:239]
    s_waitcnt vmcnt(11)
    v_mfma_f32_16x16x32_bf16 v[208:211], v[112:115], v[84:87], v[208:211]
    buffer_load_dwordx4 v[68:71], v13, s[64:67], s15 offen sc1
    v_mfma_f32_16x16x32_bf16 v[212:215], v[116:119], v[84:87], v[212:215]
    v_mfma_f32_16x16x32_bf16 v[216:219], v[120:123], v[84:87], v[216:219]
    v_mfma_f32_16x16x32_bf16 v[220:223], v[124:127], v[84:87], v[220:223]
    s_waitcnt vmcnt(11)
    v_mfma_f32_16x16x32_bf16 v[192:195], v[112:115], v[80:83], v[192:195]
    buffer_load_dwordx4 v[64:67], v12, s[64:67], s15 offen sc1
    v_mfma_f32_16x16x32_bf16 v[196:199], v[116:119], v[80:83], v[196:199]
    v_mfma_f32_16x16x32_bf16 v[200:203], v[120:123], v[80:83], v[200:203]
    v_mfma_f32_16x16x32_bf16 v[204:207], v[124:127], v[80:83], v[204:207]
    s_waitcnt lgkmcnt(15)
    s_waitcnt vmcnt(11)
    v_mfma_f32_16x16x32_bf16 v[240:243], v[128:131], v[44:47], v[240:243]
    s_add_u32 s15, s41, 4096
    buffer_load_dwordx4 v[92:95], v15, s[64:67], s15 offen sc1
    v_mfma_f32_16x16x32_bf16 v[244:247], v[132:135], v[44:47], v[244:247]
    s_waitcnt vmcnt(24)
    ds_read_b64_tr_b16 v[112:113], v24 offset:16384
    v_mfma_f32_16x16x32_bf16 v[248:251], v[136:139], v[44:47], v[248:251]
    ds_read_b64_tr_b16 v[116:117], v25 offset:16384
    ds_read_b64_tr_b16 v[120:121], v26 offset:16384
    v_mfma_f32_16x16x32_bf16 v[252:255], v[140:143], v[44:47], v[252:255]
    ds_read_b64_tr_b16 v[124:125], v27 offset:16384
    s_waitcnt vmcnt(20)
    s_waitcnt vmcnt(11)
    v_mfma_f32_16x16x32_bf16 v[224:227], v[128:131], v[40:43], v[224:227]
    buffer_load_dwordx4 v[88:91], v14, s[64:67], s15 offen sc1
    v_mfma_f32_16x16x32_bf16 v[228:231], v[132:135], v[40:43], v[228:231]
    ds_read_b64_tr_b16 v[114:115], v24 offset:24576
    ds_read_b64_tr_b16 v[118:119], v25 offset:24576
    v_mfma_f32_16x16x32_bf16 v[232:235], v[136:139], v[40:43], v[232:235]
    ds_read_b64_tr_b16 v[122:123], v26 offset:24576
    ds_read_b64_tr_b16 v[126:127], v27 offset:24576
    v_mfma_f32_16x16x32_bf16 v[236:239], v[140:143], v[40:43], v[236:239]
    s_waitcnt vmcnt(11)
    v_mfma_f32_16x16x32_bf16 v[208:211], v[128:131], v[36:39], v[208:211]
    buffer_load_dwordx4 v[84:87], v13, s[64:67], s15 offen sc1
    v_mfma_f32_16x16x32_bf16 v[212:215], v[132:135], v[36:39], v[212:215]
    v_mfma_f32_16x16x32_bf16 v[216:219], v[136:139], v[36:39], v[216:219]
    v_mfma_f32_16x16x32_bf16 v[220:223], v[140:143], v[36:39], v[220:223]
    s_waitcnt vmcnt(11)
    v_mfma_f32_16x16x32_bf16 v[192:195], v[128:131], v[32:35], v[192:195]
    buffer_load_dwordx4 v[80:83], v12, s[64:67], s15 offen sc1
    v_mfma_f32_16x16x32_bf16 v[196:199], v[132:135], v[32:35], v[196:199]
    v_mfma_f32_16x16x32_bf16 v[200:203], v[136:139], v[32:35], v[200:203]
    v_mfma_f32_16x16x32_bf16 v[204:207], v[140:143], v[32:35], v[204:207]
    s_waitcnt lgkmcnt(0)
    s_load_dwordx16 s[16:31], s[46:47], s74 glc
    s_load_dword s32, s[46:47], s75 glc
    s_waitcnt vmcnt(11)
    v_mfma_f32_16x16x32_bf16 v[240:243], v[144:147], v[60:63], v[240:243]
    s_add_u32 s15, s41, 5120
    buffer_load_dwordx4 v[44:47], v15, s[64:67], s15 offen sc1
    v_mfma_f32_16x16x32_bf16 v[244:247], v[148:151], v[60:63], v[244:247]
    v_mfma_f32_16x16x32_bf16 v[248:251], v[152:155], v[60:63], v[248:251]
    v_mfma_f32_16x16x32_bf16 v[252:255], v[156:159], v[60:63], v[252:255]
    s_waitcnt vmcnt(11)
    v_mfma_f32_16x16x32_bf16 v[224:227], v[144:147], v[56:59], v[224:227]
    buffer_load_dwordx4 v[40:43], v14, s[64:67], s15 offen sc1
    v_mfma_f32_16x16x32_bf16 v[228:231], v[148:151], v[56:59], v[228:231]
    v_mfma_f32_16x16x32_bf16 v[232:235], v[152:155], v[56:59], v[232:235]
    v_mfma_f32_16x16x32_bf16 v[236:239], v[156:159], v[56:59], v[236:239]
    s_waitcnt vmcnt(11)
    v_mfma_f32_16x16x32_bf16 v[208:211], v[144:147], v[52:55], v[208:211]
    buffer_load_dwordx4 v[36:39], v13, s[64:67], s15 offen sc1
    v_mfma_f32_16x16x32_bf16 v[212:215], v[148:151], v[52:55], v[212:215]
    v_mfma_f32_16x16x32_bf16 v[216:219], v[152:155], v[52:55], v[216:219]
    v_mfma_f32_16x16x32_bf16 v[220:223], v[156:159], v[52:55], v[220:223]
    s_waitcnt vmcnt(11)
    v_mfma_f32_16x16x32_bf16 v[192:195], v[144:147], v[48:51], v[192:195]
    buffer_load_dwordx4 v[32:35], v12, s[64:67], s15 offen sc1
    v_mfma_f32_16x16x32_bf16 v[196:199], v[148:151], v[48:51], v[196:199]
    v_mfma_f32_16x16x32_bf16 v[200:203], v[152:155], v[48:51], v[200:203]
    v_mfma_f32_16x16x32_bf16 v[204:207], v[156:159], v[48:51], v[204:207]
    s_waitcnt vmcnt(11)
    v_mfma_f32_16x16x32_bf16 v[240:243], v[160:163], v[76:79], v[240:243]
    s_add_u32 s15, s41, 6144
    buffer_load_dwordx4 v[60:63], v15, s[64:67], s15 offen sc1
    v_mfma_f32_16x16x32_bf16 v[244:247], v[164:167], v[76:79], v[244:247]
    v_mfma_f32_16x16x32_bf16 v[248:251], v[168:171], v[76:79], v[248:251]
    v_mfma_f32_16x16x32_bf16 v[252:255], v[172:175], v[76:79], v[252:255]
    s_waitcnt vmcnt(11)
    v_mfma_f32_16x16x32_bf16 v[224:227], v[160:163], v[72:75], v[224:227]
    buffer_load_dwordx4 v[56:59], v14, s[64:67], s15 offen sc1
    v_mfma_f32_16x16x32_bf16 v[228:231], v[164:167], v[72:75], v[228:231]
    v_mfma_f32_16x16x32_bf16 v[232:235], v[168:171], v[72:75], v[232:235]
    v_mfma_f32_16x16x32_bf16 v[236:239], v[172:175], v[72:75], v[236:239]
    s_waitcnt vmcnt(11)
    v_mfma_f32_16x16x32_bf16 v[208:211], v[160:163], v[68:71], v[208:211]
    buffer_load_dwordx4 v[52:55], v13, s[64:67], s15 offen sc1
    v_mfma_f32_16x16x32_bf16 v[212:215], v[164:167], v[68:71], v[212:215]
    v_mfma_f32_16x16x32_bf16 v[216:219], v[168:171], v[68:71], v[216:219]
    v_mfma_f32_16x16x32_bf16 v[220:223], v[172:175], v[68:71], v[220:223]
    s_waitcnt vmcnt(11)
    v_mfma_f32_16x16x32_bf16 v[192:195], v[160:163], v[64:67], v[192:195]
    buffer_load_dwordx4 v[48:51], v12, s[64:67], s15 offen sc1
    v_mfma_f32_16x16x32_bf16 v[196:199], v[164:167], v[64:67], v[196:199]
    v_mfma_f32_16x16x32_bf16 v[200:203], v[168:171], v[64:67], v[200:203]
    v_mfma_f32_16x16x32_bf16 v[204:207], v[172:175], v[64:67], v[204:207]
    s_mov_b32 s3, 0
L_poll4:
    s_waitcnt lgkmcnt(0)
    s_mov_b32 s33, s32
    s_xor_b64 s[16:17], s[16:17], s[68:69]
    s_xor_b64 s[18:19], s[18:19], s[68:69]
    s_xor_b64 s[20:21], s[20:21], s[68:69]
    s_xor_b64 s[22:23], s[22:23], s[68:69]
    s_xor_b64 s[24:25], s[24:25], s[68:69]
    s_xor_b64 s[26:27], s[26:27], s[68:69]
    s_xor_b64 s[28:29], s[28:29], s[68:69]
    s_xor_b64 s[30:31], s[30:31], s[68:69]
    s_xor_b64 s[32:33], s[32:33], s[68:69]
    s_or_b64 s[16:17], s[16:17], s[18:19]
    s_or_b64 s[16:17], s[16:17], s[20:21]
    s_or_b64 s[16:17], s[16:17], s[22:23]
    s_or_b64 s[16:17], s[16:17], s[24:25]
    s_or_b64 s[16:17], s[16:17], s[26:27]
    s_or_b64 s[16:17], s[16:17], s[28:29]
    s_or_b64 s[16:17], s[16:17], s[30:31]
    s_or_b64 s[16:17], s[16:17], s[32:33]
    s_cbranch_scc0 L_pollx4
    s_add_u32 s3, s3, 1
    s_cmp_gt_u32 s3, 40000
    s_cbranch_scc1 L_pollx4
    s_sleep 4
    s_load_dwordx16 s[16:31], s[46:47], s74 glc
    s_load_dword s32, s[46:47], s75 glc
    s_branch L_poll4
L_pollx4:
    buffer_load_dwordx4 v[128:131], v16, s[64:67], 0 offen sc1
    buffer_load_dwordx4 v[132:135], v17, s[64:67], 0 offen sc1
    buffer_load_dword v136, v19, s[64:67], 0 offen sc1
    s_waitcnt vmcnt(14)
    v_mfma_f32_16x16x32_bf16 v[240:243], v[176:179], v[92:95], v[240:243]
    v_mfma_f32_16x16x32_bf16 v[244:247], v[180:183], v[92:95], v[244:247]
    v_mfma_f32_16x16x32_bf16 v[248:251], v[184:187], v[92:95], v[248:251]
    v_mfma_f32_16x16x32_bf16 v[252:255], v[188:191], v[92:95], v[252:255]
    s_waitcnt vmcnt(13)
    v_mfma_f32_16x16x32_bf16 v[224:227], v[176:179], v[88:91], v[224:227]
    v_mfma_f32_16x16x32_bf16 v[228:231], v[180:183], v[88:91], v[228:231]
    v_mfma_f32_16x16x32_bf16 v[232:235], v[184:187], v[88:91], v[232:235]
    v_mfma_f32_16x16x32_bf16 v[236:239], v[188:191], v[88:91], v[236:239]
    s_waitcnt vmcnt(12)
    v_mfma_f32_16x16x32_bf16 v[208:211], v[176:179], v[84:87], v[208:211]
    v_mfma_f32_16x16x32_bf16 v[212:215], v[180:183], v[84:87], v[212:215]
    v_mfma_f32_16x16x32_bf16 v[216:219], v[184:187], v[84:87], v[216:219]
    v_mfma_f32_16x16x32_bf16 v[220:223], v[188:191], v[84:87], v[220:223]
    s_waitcnt vmcnt(11)
    v_mfma_f32_16x16x32_bf16 v[192:195], v[176:179], v[80:83], v[192:195]
    v_mfma_f32_16x16x32_bf16 v[196:199], v[180:183], v[80:83], v[196:199]
    v_mfma_f32_16x16x32_bf16 v[200:203], v[184:187], v[80:83], v[200:203]
    v_mfma_f32_16x16x32_bf16 v[204:207], v[188:191], v[80:83], v[204:207]
    s_waitcnt vmcnt(10)
    v_mfma_f32_16x16x32_bf16 v[240:243], v[96:99], v[44:47], v[240:243]
    v_mfma_f32_16x16x32_bf16 v[244:247], v[100:103], v[44:47], v[244:247]
    v_mfma_f32_16x16x32_bf16 v[248:251], v[104:107], v[44:47], v[248:251]
    v_mfma_f32_16x16x32_bf16 v[252:255], v[108:111], v[44:47], v[252:255]
    s_waitcnt vmcnt(6)
    v_mfma_f32_16x16x32_bf16 v[240:243], v[112:115], v[60:63], v[240:243]
    v_mfma_f32_16x16x32_bf16 v[244:247], v[116:119], v[60:63], v[244:247]
    v_mfma_f32_16x16x32_bf16 v[248:251], v[120:123], v[60:63], v[248:251]
    v_mfma_f32_16x16x32_bf16 v[252:255], v[124:127], v[60:63], v[252:255]
    s_waitcnt vmcnt(9)
    v_mfma_f32_16x16x32_bf16 v[224:227], v[96:99], v[40:43], v[224:227]
    v_mfma_f32_16x16x32_bf16 v[228:231], v[100:103], v[40:43], v[228:231]
    v_mfma_f32_16x16x32_bf16 v[232:235], v[104:107], v[40:43], v[232:235]
    s_nop 0
    ds_write_b128 v28, v[240:243] offset:32768
    v_mfma_f32_16x16x32_bf16 v[236:239], v[108:111], v[40:43], v[236:239]
    ds_write_b128 v28, v[244:247] offset:33792
    s_waitcnt vmcnt(5)
    v_mfma_f32_16x16x32_bf16 v[224:227], v[112:115], v[56:59], v[224:227]
    ds_write_b128 v28, v[248:251] offset:40960
    v_mfma_f32_16x16x32_bf16 v[228:231], v[116:119], v[56:59], v[228:231]
    ds_write_b128 v28, v[252:255] offset:41984
    v_mfma_f32_16x16x32_bf16 v[232:235], v[120:123], v[56:59], v[232:235]
    v_mfma_f32_16x16x32_bf16 v[236:239], v[124:127], v[56:59], v[236:239]
    s_waitcnt vmcnt(8)
    v_mfma_f32_16x16x32_bf16 v[208:211], v[96:99], v[36:39], v[208:211]
    v_mfma_f32_16x16x32_bf16 v[212:215], v[100:103], v[36:39], v[212:215]
    v_mfma_f32_16x16x32_bf16 v[216:219], v[104:107], v[36:39], v[216:219]
    ds_write_b128 v28, v[224:227] offset:16384
    v_mfma_f32_16x16x32_bf16 v[220:223], v[108:111], v[36:39], v[220:223]
    ds_write_b128 v28, v[228:231] offset:17408
    s_waitcnt vmcnt(4)
    v_mfma_f32_16x16x32_bf16 v[208:211], v[112:115], v[52:55], v[208:211]
    ds_write_b128 v28, v[232:235] offset:24576
    v_mfma_f32_16x16x32_bf16 v[212:215], v[116:119], v[52:55], v[212:215]
    ds_write_b128 v28, v[236:239] offset:25600
    v_mfma_f32_16x16x32_bf16 v[216:219], v[120:123], v[52:55], v[216:219]
    v_mfma_f32_16x16x32_bf16 v[220:223], v[124:127], v[52:55], v[220:223]
    s_waitcnt vmcnt(7)
    v_mfma_f32_16x16x32_bf16 v[192:195], v[96:99], v[32:35], v[192:195]
    v_mfma_f32_16x16x32_bf16 v[196:199], v[100:103], v[32:35], v[196:199]
    v_mfma_f32_16x16x32_bf16 v[200:203], v[104:107], v[32:35], v[200:203]
    ds_write_b128 v28, v[208:211] offset:0
    v_mfma_f32_16x16x32_bf16 v[204:207], v[108:111], v[32:35], v[204:207]
    ds_write_b128 v28, v[212:215] offset:1024
    s_waitcnt vmcnt(3)
    v_mfma_f32_16x16x32_bf16 v[192:195], v[112:115], v[48:51], v[192:195]
    ds_write_b128 v28, v[216:219] offset:8192
    v_mfma_f32_16x16x32_bf16 v[196:199], v[116:119], v[48:51], v[196:199]
    ds_write_b128 v28, v[220:223] offset:9216
    v_mfma_f32_16x16x32_bf16 v[200:203], v[120:123], v[48:51], v[200:203]
    v_mfma_f32_16x16x32_bf16 v[204:207], v[124:127], v[48:51], v[204:207]
    s_waitcnt vmcnt(0)
    ds_write_b128 v18, v[128:131] offset:49152
    ds_write_b128 v18, v[132:135] offset:50176
    s_waitcnt lgkmcnt(0)
    s_barrier
    ds_read_b64_tr_b16 v[80:81], v20 offset:49152
    ds_read_b64_tr_b16 v[82:83], v20 offset:51200
    ds_read_b64_tr_b16 v[84:85], v20 offset:53248
    ds_read_b64_tr_b16 v[86:87], v20 offset:55296
    ds_read_b128 v[32:35], v29 offset:0
    ds_read_b128 v[36:39], v29 offset:1024
    ds_read_b128 v[48:51], v30 offset:16384
    ds_read_b128 v[52:55], v30 offset:17408
    ds_read_b128 v[64:67], v31 offset:32768
    ds_read_b128 v[68:71], v31 offset:33792
    ds_read_b128 v[40:43], v29 offset:8192
    ds_read_b128 v[44:47], v29 offset:9216
    ds_read_b128 v[56:59], v30 offset:24576
    ds_read_b128 v[60:63], v30 offset:25600
    ds_read_b128 v[72:75], v31 offset:40960
    ds_read_b128 v[76:79], v31 offset:41984
    s_waitcnt lgkmcnt(12)
    v_lshlrev_b32 v224, 16, v80
    v_and_b32 v225, 0xffff0000, v80
    v_lshlrev_b32 v226, 16, v81
    v_and_b32 v227, 0xffff0000, v81
    v_lshlrev_b32 v228, 16, v82
    v_and_b32 v229, 0xffff0000, v82
    v_lshlrev_b32 v230, 16, v83
    v_and_b32 v231, 0xffff0000, v83
    v_lshlrev_b32 v232, 16, v84
    v_and_b32 v233, 0xffff0000, v84
    v_lshlrev_b32 v234, 16, v85
    v_and_b32 v235, 0xffff0000, v85
    v_lshlrev_b32 v236, 16, v86
    v_and_b32 v237, 0xffff0000, v86
    v_lshlrev_b32 v238, 16, v87
    v_and_b32 v239, 0xffff0000, v87
    s_waitcnt lgkmcnt(10)
    v_pk_add_f32 v[192:193], v[192:193], v[32:33]
    v_pk_add_f32 v[194:195], v[194:195], v[34:35]
    v_pk_add_f32 v[196:197], v[196:197], v[36:37]
    v_pk_add_f32 v[198:199], v[198:199], v[38:39]
    s_waitcnt lgkmcnt(8)
    v_pk_add_f32 v[192:193], v[192:193], v[48:49]
    v_pk_add_f32 v[194:195], v[194:195], v[50:51]
    v_pk_add_f32 v[196:197], v[196:197], v[52:53]
    v_pk_add_f32 v[198:199], v[198:199], v[54:55]
    s_waitcnt lgkmcnt(6)
    v_pk_add_f32 v[192:193], v[192:193], v[64:65]
    v_pk_add_f32 v[194:195], v[194:195], v[66:67]
    v_pk_add_f32 v[196:197], v[196:197], v[68:69]
    v_pk_add_f32 v[198:199], v[198:199], v[70:71]
    v_pk_add_f32 v[224:225], v[224:225], v[192:193] neg_lo:[0,1] neg_hi:[0,1]
    v_pk_add_f32 v[226:227], v[226:227], v[194:195] neg_lo:[0,1] neg_hi:[0,1]
    v_pk_add_f32 v[228:229], v[228:229], v[196:197] neg_lo:[0,1] neg_hi:[0,1]
    v_pk_add_f32 v[230:231], v[230:231], v[198:199] neg_lo:[0,1] neg_hi:[0,1]
    v_pk_fma_f32 v[192:193], v[224:225], v[136:137], v[192:193] op_sel_hi:[1,0,1]
    v_pk_fma_f32 v[194:195], v[226:227], v[136:137], v[194:195] op_sel_hi:[1,0,1]
    v_pk_fma_f32 v[196:197], v[228:229], v[136:137], v[196:197] op_sel_hi:[1,0,1]
    v_pk_fma_f32 v[198:199], v[230:231], v[136:137], v[198:199] op_sel_hi:[1,0,1]
    v_cvt_pk_bf16_f32 v240, v192, v193
    v_cvt_pk_bf16_f32 v241, v194, v195
    v_cvt_pk_bf16_f32 v242, v196, v197
    v_cvt_pk_bf16_f32 v243, v198, v199
    s_nop 0
    v_permlane16_swap_b32 v240, v242
    v_permlane16_swap_b32 v241, v243
    buffer_store_dwordx4 v[240:243], v21, s[60:63], s70 offen offset:0
    s_waitcnt lgkmcnt(4)
    v_pk_add_f32 v[200:201], v[200:201], v[40:41]
    v_pk_add_f32 v[202:203], v[202:203], v[42:43]
    v_pk_add_f32 v[204:205], v[204:205], v[44:45]
    v_pk_add_f32 v[206:207], v[206:207], v[46:47]
    s_waitcnt lgkmcnt(2)
    v_pk_add_f32 v[200:201], v[200:201], v[56:57]
    v_pk_add_f32 v[202:203], v[202:203], v[58:59]
    v_pk_add_f32 v[204:205], v[204:205], v[60:61]
    v_pk_add_f32 v[206:207], v[206:207], v[62:63]
    s_waitcnt lgkmcnt(0)
    v_pk_add_f32 v[200:201], v[200:201], v[72:73]
    v_pk_add_f32 v[202:203], v[202:203], v[74:75]
    v_pk_add_f32 v[204:205], v[204:205], v[76:77]
    v_pk_add_f32 v[206:207], v[206:207], v[78:79]
    v_pk_add_f32 v[232:233], v[232:233], v[200:201] neg_lo:[0,1] neg_hi:[0,1]
    v_pk_add_f32 v[234:235], v[234:235], v[202:203] neg_lo:[0,1] neg_hi:[0,1]
    v_pk_add_f32 v[236:237], v[236:237], v[204:205] neg_lo:[0,1] neg_hi:[0,1]
    v_pk_add_f32 v[238:239], v[238:239], v[206:207] neg_lo:[0,1] neg_hi:[0,1]
    v_pk_fma_f32 v[200:201], v[232:233], v[136:137], v[200:201] op_sel_hi:[1,0,1]
    v_pk_fma_f32 v[202:203], v[234:235], v[136:137], v[202:203] op_sel_hi:[1,0,1]
    v_pk_fma_f32 v[204:205], v[236:237], v[136:137], v[204:205] op_sel_hi:[1,0,1]
    v_pk_fma_f32 v[206:207], v[238:239], v[136:137], v[206:207] op_sel_hi:[1,0,1]
    v_cvt_pk_bf16_f32 v244, v200, v201
    v_cvt_pk_bf16_f32 v245, v202, v203
    v_cvt_pk_bf16_f32 v246, v204, v205
    v_cvt_pk_bf16_f32 v247, v206, v207
    s_nop 0
    v_permlane16_swap_b32 v244, v246
    v_permlane16_swap_b32 v245, v247
    buffer_store_dwordx4 v[244:247], v21, s[60:63], s70 offen offset:64
    s_endpgm
L_roleB0:
    s_setprio 3
    s_lshr_b32 s9, s6, 1
    s_lshl1_add_u32 s8, s5, s9
    s_lshl3_add_u32 s77, s8, s4
    s_and_b32 s9, s6, 1
    s_lshl1_add_u32 s8, s77, s9
    s_lshl_b32 s8, s8, 7
    v_lshl_add_u32 v24, v1, 1, s8
    v_lshlrev_b32 v25, 1, s77
    v_pk_mov_b32 v[176:177], 0, 0
    v_pk_mov_b32 v[178:179], 0, 0
    v_pk_mov_b32 v[180:181], 0, 0
    v_pk_mov_b32 v[182:183], 0, 0
    ds_write_b128 v176, v[176:179] offset:64384
    s_waitcnt lgkmcnt(0)
    s_barrier
    global_load_short_d16_hi v176, v24, s[18:19]
    global_load_short_d16_hi v177, v24, s[20:21]
    global_load_short_d16_hi v178, v24, s[22:23]
    global_load_short_d16_hi v179, v24, s[24:25]
    global_load_short_d16_hi v180, v24, s[26:27]
    global_load_short_d16_hi v181, v24, s[28:29]
    global_load_short_d16_hi v182, v25, s[30:31]
    global_load_short_d16_hi v183, v25, s[32:33]
L_roleB:
    v_mov_b32 v3, 0
    v_lshlrev_b32 v7, 4, v1
    s_mov_b32 s66, 12582912
    s_mov_b32 s67, 0x00020000
    s_mov_b64 s[64:65], s[46:47]
    s_mov_b64 s[48:49], s[16:17]
    s_cmp_eq_u32 s6, 1
    s_cselect_b64 s[8:9], s[38:39], s[46:47]
    s_cmp_eq_u32 s6, 2
    s_cselect_b64 s[8:9], s[42:43], s[8:9]
    s_cmp_eq_u32 s6, 3
    s_cselect_b64 s[8:9], s[44:45], s[8:9]
    s_cmp_eq_u32 s6, 0
    s_cselect_b32 s10, 5, 0
    s_mov_b32 s11, 21
    v_min_u32 v8, s10, v1
    v_lshlrev_b32 v8, s11, v8
    global_load_dword v6, v8, s[8:9] offset:128
    v_lshrrev_b32 v8, 3, v1
    v_lshl_add_u32 v8, v4, 5, v8
    v_lshlrev_b32 v8, 10, v8
    v_lshrrev_b32 v9, 4, v1
    v_and_b32 v10, 7, v1
    v_xor_b32 v10, v10, v9
    v_lshl_add_u32 v16, v10, 4, v8
    v_xor_b32 v10, 4, v10
    v_lshl_add_u32 v17, v10, 4, v8
    v_add_u32 v17, 7168, v17
    v_add_u32 v18, 14336, v16
    v_add_u32 v19, 14336, v17
    v_lshl_add_u32 v8, v4, 4, v9
    v_mul_u32_u24 v8, 3584, v8
    v_and_b32 v10, 15, v1
    v_lshlrev_b32 v11, 2, v9
    v_xor_b32 v10, v10, v11
    v_lshl_add_u32 v20, v10, 4, v8
    v_add_u32 v21, 13312, v20
    v_xor_b32 v10, 2, v10
    v_lshl_add_u32 v8, v10, 4, v8
    v_add_u32 v22, 26624, v8
    v_add_u32 v23, 39936, v8
    s_mov_b64 s[52:53], s[36:37]
    s_lshl_b32 s36, s6, 8
    s_lshr_b32 s8, s6, 1
    s_lshl_b32 s9, s8, 9
    v_and_b32 v8, 15, v1
    v_lshrrev_b32 v9, 4, v1
    v_lshl_add_u32 v10, v9, 4, s9
    s_movk_i32 s10, 1056
    v_add_u32 v12, 46, v8
    v_mad_u32_u24 v240, v12, s10, v10
    s_and_b32 s11, s6, 1
    s_cmp_eq_u32 s11, 0
    s_cselect_b64 vcc, -1, 0
    v_lshrrev_b32 v11, 2, v8
    v_and_b32 v4, 3, v8
    v_min_u32 v5, 2, v4
    v_lshrrev_b32 v13, 1, v11
    v_lshl_add_u32 v12, v11, 1, v13
    v_add3_u32 v12, v12, v5, 24
    v_add_u32 v13, 0, v8
    v_cndmask_b32 v12, v12, v13, vcc
    v_mad_u32_u24 v241, v12, s10, v10
    v_mad_u32_u24 v12, v11, 3, v5
    v_add_u32 v12, 34, v12
    v_lshl_add_u32 v13, v11, 1, v4
    v_add_u32 v13, 16, v13
    v_cmp_gt_u32 s[12:13], 2, v4
    s_nop 1
    v_cndmask_b32 v13, 24, v13, s[12:13]
    v_cndmask_b32 v12, v12, v13, vcc
    v_mad_u32_u24 v242, v12, s10, v10
    v_add_u32 v12, 16, v1
    v_subrev_u32 v13, 47, v1
    v_cmp_gt_u32 s[12:13], 48, v1
    s_nop 1
    v_cndmask_b32 v12, v13, v12, s[12:13]
    v_lshlrev_b32 v243, 2, v12
    s_mul_i32 s9, s8, 16640
    v_lshlrev_b32 v11, 5, v8
    v_sub_u32 v11, s9, v11
    v_lshlrev_b32 v12, 3, v9
    v_sub_u32 v12, v11, v12
    v_add_u32 v12, 3576, v12
    v_lshrrev_b32 v13, 1, v9
    v_lshlrev_b32 v13, 9, v13
    v_and_b32 v4, 1, v9
    v_lshl_add_u32 v13, v4, 4, v13
    v_sub_u32 v13, v11, v13
    v_add_u32 v13, 3056, v13
    v_cndmask_b32 v244, v13, v12, vcc
    v_lshlrev_b32 v13, 9, v9
    v_sub_u32 v13, v11, v13
    v_add_u32 v245, 2016, v13
    s_movk_i32 s10, 4160
    v_lshrrev_b32 v11, 3, v1
    v_and_b32 v12, 7, v1
    v_lshlrev_b32 v12, 3, v12
    v_mad_u32_u24 v12, v11, s10, v12
    s_add_u32 s12, s9, 4096
    v_add_u32 v252, s12, v12
    v_add_u32 v11, 1, v8
    v_and_b32 v11, 3, v11
    v_sub_u32 v12, 18, v8
    v_and_b32 v12, 28, v12
    v_lshl_add_u32 v12, v9, 3, v12
    v_lshlrev_b32 v12, 1, v12
    v_mad_u32_u24 v12, v11, s10, v12
    s_xor_b32 s13, s11, 1
    s_lshl_b32 s13, s13, 8
    s_add_u32 s12, s9, s13
    v_add_u32 v247, s12, v12
    v_lshlrev_b32 v12, 5, v8
    v_lshl_add_u32 v12, v9, 4, v12
    s_mul_i32 s12, s8, 4608
    s_add_u32 s12, s12, 33280
    s_add_u32 s13, s12, s13
    v_add_u32 v248, s13, v12
    v_min_u32 v11, 59, v1
    v_lshl_add_u32 v254, v11, 3, s12
    v_mov_b32 v5, 1
    v_lshrrev_b32 v8, 1, v1
    v_and_b32 v9, 1, v1
    v_bfe_u32 v10, v1, 2, 3
    s_lshr_b32 s9, s5, 1
    v_xor_b32 v10, s9, v10
    v_lshrrev_b32 v11, 2, v1
    v_lshl_add_u32 v10, v11, 4, v10
    v_and_b32 v11, 1, v8
    v_lshl_add_u32 v10, v10, 1, v11
    s_and_b32 s9, s5, 1
    v_lshl_add_u32 v10, v10, 1, s9
    v_lshl_add_u32 v10, v10, 1, v9
    v_lshlrev_b32 v251, 4, v10
    s_lshl_b32 s8, s6, 16
    s_lshl_b32 s9, s4, 18
    s_add_u32 s8, s8, s9
    s_add_u32 s32, s8, 1048576
    s_add_u32 s33, s32, 32768
    s_movk_i32 s8, 4608
    v_lshlrev_b32 v8, 4, v8
    v_mad_u32_u24 v8, v9, s8, v8
    s_lshl_b32 s8, s6, 10
    s_add_u32 s9, s8, 33760
    v_add_u32 v246, s9, v8
    s_lshl_b32 s8, s6, 10
    s_add_u32 s8, s8, 4096
    v_and_b32 v8, 7, v1
    v_lshl_add_u32 v253, v8, 7, s8
    s_lshl_b32 s8, s77, 10
    s_lshl_b32 s10, s11, 20
    s_add_u32 s8, s8, s10
    s_add_u32 s34, s8, 3145728
    s_add_u32 s38, s34, 0x80000
    v_bfe_u32 v8, v1, 2, 3
    v_xor_b32 v8, s4, v8
    v_lshrrev_b32 v9, 5, v1
    v_lshl_add_u32 v8, v8, 1, v9
    v_and_b32 v9, 3, v1
    v_lshl_add_u32 v8, v8, 2, v9
    v_lshlrev_b32 v255, 4, v8
    s_lshl_b32 s8, s11, 12
    s_lshr_b32 s10, s77, 4
    s_lshl_b32 s10, s10, 7
    s_add_u32 s8, s8, s10
    s_and_b32 s10, s77, 15
    s_lshl2_add_u32 s8, s10, s8
    s_add_u32 s35, s8, 393216
    s_lshl_b32 s8, s6, 12
    s_add_u32 s8, s8, 42496
    v_add_u32 v250, s8, v7
    s_xor_b32 s8, s6, 1
    s_lshl_b32 s8, s8, 12
    s_add_u32 s8, s8, 42496
    v_add_u32 v249, s8, v7
    s_cmp_lt_u32 s5, 28
    s_cbranch_scc1 L_nh0
    s_setprio 0
L_nh0:
    s_waitcnt vmcnt(1)
.p2align 3
    v_mul_f32 v134, 0x3fb8aa3b, v182
    v_exp_f32 v134, v134
    v_pk_mul_f32 v[138:139], v[180:181], v[178:179] op_sel_hi:[1,0]
    v_cvt_pk_bf16_f32 v134, v134, v134
    v_pk_fma_f32 v[138:139], v[180:181], v[178:179], v[138:139] op_sel:[1,1,0] op_sel_hi:[0,1,1] neg_lo:[1,0,0]
    v_and_b32 v134, 0xffff0000, v134
    v_mov_b32 v32, 0x3f80
    v_mul_f32 v135, v134, v176
    v_mul_f32 v136, v134, v177
    v_pk_mul_f32 v[130:131], v[138:139], v[134:135] op_sel_hi:[1,0]
    v_mul_f32 v135, 0x3fb8aa3b, v135
    v_mul_f32 v136, 0.15915494, v136
    v_mul_f32 v142, 0x41800000, v135
    v_mul_f32 v143, 0x41800000, v136
    v_mul_f32 v144, 0x43800000, v135
    v_mul_f32 v145, 0x43800000, v136
    v_fract_f32 v141, v136
    v_fract_f32 v143, v143
    v_fract_f32 v145, v145
    v_exp_f32 v140, v135
    v_exp_f32 v142, v142
    v_exp_f32 v144, v144
    v_cos_f32 v80, v141
    v_sin_f32 v81, v141
    v_cos_f32 v110, v143
    v_sin_f32 v111, v143
    v_cos_f32 v116, v145
    v_sin_f32 v117, v145
    v_pk_mul_f32 v[80:81], v[80:81], v[140:141] op_sel_hi:[1,0]
    v_pk_mul_f32 v[110:111], v[110:111], v[142:143] op_sel_hi:[1,0]
    v_pk_mul_f32 v[116:117], v[116:117], v[144:145] op_sel_hi:[1,0]
    v_pk_mul_f32 v[132:133], v[130:131], v[110:111] op_sel_hi:[1,0]
    v_pk_mul_f32 v[82:83], v[80:81], v[80:81] op_sel_hi:[1,0]
    v_pk_mul_f32 v[118:119], v[116:117], v[116:117] op_sel_hi:[1,0]
    v_cvt_pk_bf16_f32 v78, v130, -v131
    v_cvt_pk_bf16_f32 v33, v80, v81
    v_cvt_pk_bf16_f32 v48, v116, v117
    v_pk_fma_f32 v[132:133], v[130:131], v[110:111], v[132:133] op_sel:[1,1,0] op_sel_hi:[0,1,1] neg_lo:[1,0,0]
    v_pk_fma_f32 v[82:83], v[80:81], v[80:81], v[82:83] op_sel:[1,1,0] op_sel_hi:[0,1,1] neg_lo:[1,0,0]
    v_pk_fma_f32 v[118:119], v[116:117], v[116:117], v[118:119] op_sel:[1,1,0] op_sel_hi:[0,1,1] neg_lo:[1,0,0]
    v_pk_mul_f32 v[130:131], v[132:133], v[110:111] op_sel_hi:[1,0]
    v_pk_mul_f32 v[84:85], v[82:83], v[80:81] op_sel_hi:[1,0]
    v_pk_mul_f32 v[120:121], v[118:119], v[116:117] op_sel_hi:[1,0]
    v_pk_mul_f32 v[86:87], v[82:83], v[82:83] op_sel_hi:[1,0]
    v_cvt_pk_bf16_f32 v79, v132, -v133
    v_cvt_pk_bf16_f32 v34, v82, v83
    v_cvt_pk_bf16_f32 v56, v118, v119
    v_pk_fma_f32 v[130:131], v[132:133], v[110:111], v[130:131] op_sel:[1,1,0] op_sel_hi:[0,1,1] neg_lo:[1,0,0]
    v_pk_fma_f32 v[84:85], v[82:83], v[80:81], v[84:85] op_sel:[1,1,0] op_sel_hi:[0,1,1] neg_lo:[1,0,0]
    v_pk_fma_f32 v[120:121], v[118:119], v[116:117], v[120:121] op_sel:[1,1,0] op_sel_hi:[0,1,1] neg_lo:[1,0,0]
    v_pk_fma_f32 v[86:87], v[82:83], v[82:83], v[86:87] op_sel:[1,1,0] op_sel_hi:[0,1,1] neg_lo:[1,0,0]
    v_pk_mul_f32 v[132:133], v[130:131], v[110:111] op_sel_hi:[1,0]
    v_pk_mul_f32 v[122:123], v[118:119], v[118:119] op_sel_hi:[1,0]
    v_pk_mul_f32 v[88:89], v[86:87], v[80:81] op_sel_hi:[1,0]
    v_cvt_pk_bf16_f32 v216, v130, -v131
    v_cvt_pk_bf16_f32 v35, v84, v85
    v_cvt_pk_bf16_f32 v61, v120, v121
    v_cvt_pk_bf16_f32 v36, v86, v87
    v_pk_fma_f32 v[132:133], v[130:131], v[110:111], v[132:133] op_sel:[1,1,0] op_sel_hi:[0,1,1] neg_lo:[1,0,0]
    v_pk_fma_f32 v[122:123], v[118:119], v[118:119], v[122:123] op_sel:[1,1,0] op_sel_hi:[0,1,1] neg_lo:[1,0,0]
    v_pk_fma_f32 v[88:89], v[86:87], v[80:81], v[88:89] op_sel:[1,1,0] op_sel_hi:[0,1,1] neg_lo:[1,0,0]
    v_pk_mul_f32 v[130:131], v[132:133], v[110:111] op_sel_hi:[1,0]
    v_pk_mul_f32 v[124:125], v[122:123], v[116:117] op_sel_hi:[1,0]
    v_pk_mul_f32 v[90:91], v[86:87], v[82:83] op_sel_hi:[1,0]
    v_pk_mul_f32 v[126:127], v[122:123], v[118:119] op_sel_hi:[1,0]
    v_cvt_pk_bf16_f32 v217, v132, -v133
    v_cvt_pk_bf16_f32 v66, v122, v123
    v_cvt_pk_bf16_f32 v37, v88, v89
    v_pk_fma_f32 v[130:131], v[132:133], v[110:111], v[130:131] op_sel:[1,1,0] op_sel_hi:[0,1,1] neg_lo:[1,0,0]
    v_pk_fma_f32 v[124:125], v[122:123], v[116:117], v[124:125] op_sel:[1,1,0] op_sel_hi:[0,1,1] neg_lo:[1,0,0]
    v_pk_fma_f32 v[90:91], v[86:87], v[82:83], v[90:91] op_sel:[1,1,0] op_sel_hi:[0,1,1] neg_lo:[1,0,0]
    v_pk_fma_f32 v[126:127], v[122:123], v[118:119], v[126:127] op_sel:[1,1,0] op_sel_hi:[0,1,1] neg_lo:[1,0,0]
    v_pk_mul_f32 v[132:133], v[130:131], v[110:111] op_sel_hi:[1,0]
    v_pk_mul_f32 v[92:93], v[86:87], v[84:85] op_sel_hi:[1,0]
    v_pk_mul_f32 v[128:129], v[122:123], v[120:121] op_sel_hi:[1,0]
    v_pk_mul_f32 v[94:95], v[86:87], v[86:87] op_sel_hi:[1,0]
    v_cvt_pk_bf16_f32 v218, v130, -v131
    v_cvt_pk_bf16_f32 v69, v124, v125
    v_cvt_pk_bf16_f32 v38, v90, v91
    v_cvt_pk_bf16_f32 v72, v126, v127
    v_pk_fma_f32 v[132:133], v[130:131], v[110:111], v[132:133] op_sel:[1,1,0] op_sel_hi:[0,1,1] neg_lo:[1,0,0]
    v_pk_fma_f32 v[92:93], v[86:87], v[84:85], v[92:93] op_sel:[1,1,0] op_sel_hi:[0,1,1] neg_lo:[1,0,0]
    v_pk_fma_f32 v[128:129], v[122:123], v[120:121], v[128:129] op_sel:[1,1,0] op_sel_hi:[0,1,1] neg_lo:[1,0,0]
    v_pk_fma_f32 v[94:95], v[86:87], v[86:87], v[94:95] op_sel:[1,1,0] op_sel_hi:[0,1,1] neg_lo:[1,0,0]
    v_pk_mul_f32 v[130:131], v[132:133], v[110:111] op_sel_hi:[1,0]
    v_pk_mul_f32 v[96:97], v[94:95], v[80:81] op_sel_hi:[1,0]
    v_pk_mul_f32 v[98:99], v[94:95], v[82:83] op_sel_hi:[1,0]
    v_pk_mul_f32 v[100:101], v[94:95], v[84:85] op_sel_hi:[1,0]
    v_cvt_pk_bf16_f32 v219, v132, -v133
    v_cvt_pk_bf16_f32 v39, v92, v93
    v_cvt_pk_bf16_f32 v75, v128, v129
    v_cvt_pk_bf16_f32 v40, v94, v95
    v_pk_fma_f32 v[130:131], v[132:133], v[110:111], v[130:131] op_sel:[1,1,0] op_sel_hi:[0,1,1] neg_lo:[1,0,0]
    v_pk_fma_f32 v[96:97], v[94:95], v[80:81], v[96:97] op_sel:[1,1,0] op_sel_hi:[0,1,1] neg_lo:[1,0,0]
    v_pk_fma_f32 v[98:99], v[94:95], v[82:83], v[98:99] op_sel:[1,1,0] op_sel_hi:[0,1,1] neg_lo:[1,0,0]
    v_pk_fma_f32 v[100:101], v[94:95], v[84:85], v[100:101] op_sel:[1,1,0] op_sel_hi:[0,1,1] neg_lo:[1,0,0]
    v_pk_mul_f32 v[132:133], v[130:131], v[110:111] op_sel_hi:[1,0]
    v_pk_mul_f32 v[102:103], v[94:95], v[86:87] op_sel_hi:[1,0]
    v_pk_mul_f32 v[104:105], v[94:95], v[88:89] op_sel_hi:[1,0]
    v_pk_mul_f32 v[106:107], v[94:95], v[90:91] op_sel_hi:[1,0]
    v_cvt_pk_bf16_f32 v220, v130, -v131
    v_cvt_pk_bf16_f32 v41, v96, v97
    v_cvt_pk_bf16_f32 v42, v98, v99
    v_cvt_pk_bf16_f32 v43, v100, v101
    v_pk_fma_f32 v[132:133], v[130:131], v[110:111], v[132:133] op_sel:[1,1,0] op_sel_hi:[0,1,1] neg_lo:[1,0,0]
    v_pk_fma_f32 v[102:103], v[94:95], v[86:87], v[102:103] op_sel:[1,1,0] op_sel_hi:[0,1,1] neg_lo:[1,0,0]
    v_pk_fma_f32 v[104:105], v[94:95], v[88:89], v[104:105] op_sel:[1,1,0] op_sel_hi:[0,1,1] neg_lo:[1,0,0]
    v_pk_fma_f32 v[106:107], v[94:95], v[90:91], v[106:107] op_sel:[1,1,0] op_sel_hi:[0,1,1] neg_lo:[1,0,0]
    v_pk_mul_f32 v[130:131], v[132:133], v[110:111] op_sel_hi:[1,0]
    v_pk_mul_f32 v[108:109], v[94:95], v[92:93] op_sel_hi:[1,0]
    v_pk_mul_f32 v[146:147], v[116:117], v[82:83] op_sel_hi:[1,0]
    v_pk_mul_f32 v[148:149], v[116:117], v[86:87] op_sel_hi:[1,0]
    v_cvt_pk_bf16_f32 v221, v132, -v133
    v_cvt_pk_bf16_f32 v44, v102, v103
    v_cvt_pk_bf16_f32 v45, v104, v105
    v_cvt_pk_bf16_f32 v46, v106, v107
    v_pk_fma_f32 v[130:131], v[132:133], v[110:111], v[130:131] op_sel:[1,1,0] op_sel_hi:[0,1,1] neg_lo:[1,0,0]
    v_pk_fma_f32 v[108:109], v[94:95], v[92:93], v[108:109] op_sel:[1,1,0] op_sel_hi:[0,1,1] neg_lo:[1,0,0]
    v_pk_fma_f32 v[146:147], v[116:117], v[82:83], v[146:147] op_sel:[1,1,0] op_sel_hi:[0,1,1] neg_lo:[1,0,0]
    v_pk_fma_f32 v[148:149], v[116:117], v[86:87], v[148:149] op_sel:[1,1,0] op_sel_hi:[0,1,1] neg_lo:[1,0,0]
    v_pk_mul_f32 v[132:133], v[130:131], v[110:111] op_sel_hi:[1,0]
    v_pk_mul_f32 v[150:151], v[116:117], v[90:91] op_sel_hi:[1,0]
    v_pk_mul_f32 v[152:153], v[116:117], v[94:95] op_sel_hi:[1,0]
    v_pk_mul_f32 v[154:155], v[116:117], v[98:99] op_sel_hi:[1,0]
    v_cvt_pk_bf16_f32 v222, v130, -v131
    v_cvt_pk_bf16_f32 v47, v108, v109
    v_cvt_pk_bf16_f32 v49, v146, v147
    v_cvt_pk_bf16_f32 v50, v148, v149
    v_pk_fma_f32 v[132:133], v[130:131], v[110:111], v[132:133] op_sel:[1,1,0] op_sel_hi:[0,1,1] neg_lo:[1,0,0]
    v_pk_fma_f32 v[150:151], v[116:117], v[90:91], v[150:151] op_sel:[1,1,0] op_sel_hi:[0,1,1] neg_lo:[1,0,0]
    v_pk_fma_f32 v[152:153], v[116:117], v[94:95], v[152:153] op_sel:[1,1,0] op_sel_hi:[0,1,1] neg_lo:[1,0,0]
    v_pk_fma_f32 v[154:155], v[116:117], v[98:99], v[154:155] op_sel:[1,1,0] op_sel_hi:[0,1,1] neg_lo:[1,0,0]
    v_pk_mul_f32 v[130:131], v[132:133], v[110:111] op_sel_hi:[1,0]
    v_pk_mul_f32 v[156:157], v[116:117], v[102:103] op_sel_hi:[1,0]
    v_pk_mul_f32 v[158:159], v[116:117], v[106:107] op_sel_hi:[1,0]
    v_pk_mul_f32 v[160:161], v[118:119], v[86:87] op_sel_hi:[1,0]
    v_cvt_pk_bf16_f32 v223, v132, -v133
    v_cvt_pk_bf16_f32 v51, v150, v151
    v_cvt_pk_bf16_f32 v52, v152, v153
    v_cvt_pk_bf16_f32 v53, v154, v155
    v_pk_fma_f32 v[130:131], v[132:133], v[110:111], v[130:131] op_sel:[1,1,0] op_sel_hi:[0,1,1] neg_lo:[1,0,0]
    v_pk_fma_f32 v[156:157], v[116:117], v[102:103], v[156:157] op_sel:[1,1,0] op_sel_hi:[0,1,1] neg_lo:[1,0,0]
    v_pk_fma_f32 v[158:159], v[116:117], v[106:107], v[158:159] op_sel:[1,1,0] op_sel_hi:[0,1,1] neg_lo:[1,0,0]
    v_pk_fma_f32 v[160:161], v[118:119], v[86:87], v[160:161] op_sel:[1,1,0] op_sel_hi:[0,1,1] neg_lo:[1,0,0]
    v_pk_mul_f32 v[132:133], v[130:131], v[110:111] op_sel_hi:[1,0]
    v_pk_mul_f32 v[162:163], v[118:119], v[94:95] op_sel_hi:[1,0]
    v_pk_mul_f32 v[164:165], v[118:119], v[102:103] op_sel_hi:[1,0]
    v_pk_mul_f32 v[166:167], v[118:119], v[110:111] op_sel_hi:[1,0]
    v_cvt_pk_bf16_f32 v224, v130, -v131
    v_cvt_pk_bf16_f32 v54, v156, v157
    v_cvt_pk_bf16_f32 v55, v158, v159
    v_cvt_pk_bf16_f32 v57, v160, v161
    v_pk_fma_f32 v[132:133], v[130:131], v[110:111], v[132:133] op_sel:[1,1,0] op_sel_hi:[0,1,1] neg_lo:[1,0,0]
    v_pk_fma_f32 v[162:163], v[118:119], v[94:95], v[162:163] op_sel:[1,1,0] op_sel_hi:[0,1,1] neg_lo:[1,0,0]
    v_pk_fma_f32 v[164:165], v[118:119], v[102:103], v[164:165] op_sel:[1,1,0] op_sel_hi:[0,1,1] neg_lo:[1,0,0]
    v_pk_fma_f32 v[166:167], v[118:119], v[110:111], v[166:167] op_sel:[1,1,0] op_sel_hi:[0,1,1] neg_lo:[1,0,0]
    v_pk_mul_f32 v[130:131], v[132:133], v[110:111] op_sel_hi:[1,0]
    v_pk_mul_f32 v[168:169], v[120:121], v[86:87] op_sel_hi:[1,0]
    v_pk_mul_f32 v[146:147], v[120:121], v[94:95] op_sel_hi:[1,0]
    v_pk_mul_f32 v[148:149], v[120:121], v[102:103] op_sel_hi:[1,0]
    v_cvt_pk_bf16_f32 v225, v132, -v133
    v_cvt_pk_bf16_f32 v58, v162, v163
    v_cvt_pk_bf16_f32 v59, v164, v165
    v_cvt_pk_bf16_f32 v60, v166, v167
    v_pk_fma_f32 v[130:131], v[132:133], v[110:111], v[130:131] op_sel:[1,1,0] op_sel_hi:[0,1,1] neg_lo:[1,0,0]
    v_pk_fma_f32 v[168:169], v[120:121], v[86:87], v[168:169] op_sel:[1,1,0] op_sel_hi:[0,1,1] neg_lo:[1,0,0]
    v_pk_fma_f32 v[146:147], v[120:121], v[94:95], v[146:147] op_sel:[1,1,0] op_sel_hi:[0,1,1] neg_lo:[1,0,0]
    v_pk_fma_f32 v[148:149], v[120:121], v[102:103], v[148:149] op_sel:[1,1,0] op_sel_hi:[0,1,1] neg_lo:[1,0,0]
    v_pk_mul_f32 v[132:133], v[130:131], v[110:111] op_sel_hi:[1,0]
    v_pk_mul_f32 v[150:151], v[120:121], v[110:111] op_sel_hi:[1,0]
    v_pk_mul_f32 v[152:153], v[122:123], v[94:95] op_sel_hi:[1,0]
    v_pk_mul_f32 v[154:155], v[122:123], v[110:111] op_sel_hi:[1,0]
    v_cvt_pk_bf16_f32 v226, v130, -v131
    v_cvt_pk_bf16_f32 v62, v168, v169
    v_cvt_pk_bf16_f32 v63, v146, v147
    v_cvt_pk_bf16_f32 v64, v148, v149
    v_pk_fma_f32 v[132:133], v[130:131], v[110:111], v[132:133] op_sel:[1,1,0] op_sel_hi:[0,1,1] neg_lo:[1,0,0]
    v_pk_fma_f32 v[150:151], v[120:121], v[110:111], v[150:151] op_sel:[1,1,0] op_sel_hi:[0,1,1] neg_lo:[1,0,0]
    v_pk_fma_f32 v[152:153], v[122:123], v[94:95], v[152:153] op_sel:[1,1,0] op_sel_hi:[0,1,1] neg_lo:[1,0,0]
    v_pk_fma_f32 v[154:155], v[122:123], v[110:111], v[154:155] op_sel:[1,1,0] op_sel_hi:[0,1,1] neg_lo:[1,0,0]
    v_pk_mul_f32 v[130:131], v[132:133], v[110:111] op_sel_hi:[1,0]
    v_pk_mul_f32 v[156:157], v[124:125], v[94:95] op_sel_hi:[1,0]
    v_pk_mul_f32 v[158:159], v[124:125], v[110:111] op_sel_hi:[1,0]
    v_pk_mul_f32 v[160:161], v[126:127], v[94:95] op_sel_hi:[1,0]
    v_cvt_pk_bf16_f32 v227, v132, -v133
    v_cvt_pk_bf16_f32 v65, v150, v151
    v_cvt_pk_bf16_f32 v67, v152, v153
    v_cvt_pk_bf16_f32 v68, v154, v155
    v_pk_fma_f32 v[130:131], v[132:133], v[110:111], v[130:131] op_sel:[1,1,0] op_sel_hi:[0,1,1] neg_lo:[1,0,0]
    v_pk_fma_f32 v[156:157], v[124:125], v[94:95], v[156:157] op_sel:[1,1,0] op_sel_hi:[0,1,1] neg_lo:[1,0,0]
    v_pk_fma_f32 v[158:159], v[124:125], v[110:111], v[158:159] op_sel:[1,1,0] op_sel_hi:[0,1,1] neg_lo:[1,0,0]
    v_pk_fma_f32 v[160:161], v[126:127], v[94:95], v[160:161] op_sel:[1,1,0] op_sel_hi:[0,1,1] neg_lo:[1,0,0]
    v_pk_mul_f32 v[132:133], v[130:131], v[110:111] op_sel_hi:[1,0]
    v_pk_mul_f32 v[162:163], v[126:127], v[110:111] op_sel_hi:[1,0]
    v_pk_mul_f32 v[164:165], v[128:129], v[94:95] op_sel_hi:[1,0]
    v_pk_mul_f32 v[166:167], v[128:129], v[110:111] op_sel_hi:[1,0]
    v_cvt_pk_bf16_f32 v228, v130, -v131
    v_cvt_pk_bf16_f32 v70, v156, v157
    v_cvt_pk_bf16_f32 v71, v158, v159
    v_cvt_pk_bf16_f32 v73, v160, v161
    v_pk_fma_f32 v[132:133], v[130:131], v[110:111], v[132:133] op_sel:[1,1,0] op_sel_hi:[0,1,1] neg_lo:[1,0,0]
    v_pk_fma_f32 v[162:163], v[126:127], v[110:111], v[162:163] op_sel:[1,1,0] op_sel_hi:[0,1,1] neg_lo:[1,0,0]
    v_pk_fma_f32 v[164:165], v[128:129], v[94:95], v[164:165] op_sel:[1,1,0] op_sel_hi:[0,1,1] neg_lo:[1,0,0]
    v_pk_fma_f32 v[166:167], v[128:129], v[110:111], v[166:167] op_sel:[1,1,0] op_sel_hi:[0,1,1] neg_lo:[1,0,0]
    v_cvt_pk_bf16_f32 v229, v132, -v133
    v_cvt_pk_bf16_f32 v74, v162, v163
    v_cvt_pk_bf16_f32 v76, v164, v165
    v_cvt_pk_bf16_f32 v77, v166, v167
    s_cmp_lt_u32 s5, 28
    s_cbranch_scc1 L_nh1
    s_mov_b32 s3, 0
L_bs5:
    s_sleep 2
    ds_read_b32 v8, v3 offset:64388
    s_add_u32 s3, s3, 1
    s_waitcnt lgkmcnt(0)
    v_readfirstlane_b32 s8, v8
    s_cmp_gt_u32 s3, 3000000
    s_cbranch_scc1 L_bsx5
    s_cmp_lt_u32 s8, 4
    s_cbranch_scc1 L_bs5
L_bsx5:
L_nh1:
    s_mov_b32 m0, s36
    s_nop 0
    ds_write_addtid_b32 v32 offset:0
    ds_write_addtid_b32 v33 offset:1056
    ds_write_addtid_b32 v34 offset:2112
    ds_write_addtid_b32 v35 offset:3168
    ds_write_addtid_b32 v36 offset:4224
    ds_write_addtid_b32 v37 offset:5280
    ds_write_addtid_b32 v38 offset:6336
    ds_write_addtid_b32 v39 offset:7392
    ds_write_addtid_b32 v40 offset:8448
    ds_write_addtid_b32 v41 offset:9504
    ds_write_addtid_b32 v42 offset:10560
    ds_write_addtid_b32 v43 offset:11616
    ds_write_addtid_b32 v44 offset:12672
    ds_write_addtid_b32 v45 offset:13728
    ds_write_addtid_b32 v46 offset:14784
    ds_write_addtid_b32 v47 offset:15840
    ds_write_addtid_b32 v48 offset:16896
    ds_write_addtid_b32 v49 offset:17952
    ds_write_addtid_b32 v50 offset:19008
    ds_write_addtid_b32 v51 offset:20064
    ds_write_addtid_b32 v52 offset:21120
    ds_write_addtid_b32 v53 offset:22176
    ds_write_addtid_b32 v54 offset:23232
    ds_write_addtid_b32 v55 offset:24288
    ds_write_addtid_b32 v56 offset:25344
    ds_write_addtid_b32 v57 offset:26400
    ds_write_addtid_b32 v58 offset:27456
    ds_write_addtid_b32 v59 offset:28512
    ds_write_addtid_b32 v60 offset:29568
    ds_write_addtid_b32 v61 offset:30624
    ds_write_addtid_b32 v62 offset:31680
    ds_write_addtid_b32 v63 offset:32736
    ds_write_addtid_b32 v64 offset:33792
    ds_write_addtid_b32 v65 offset:34848
    ds_write_addtid_b32 v66 offset:35904
    ds_write_addtid_b32 v67 offset:36960
    ds_write_addtid_b32 v68 offset:38016
    ds_write_addtid_b32 v69 offset:39072
    ds_write_addtid_b32 v70 offset:40128
    ds_write_addtid_b32 v71 offset:41184
    ds_write_addtid_b32 v72 offset:42240
    ds_write_addtid_b32 v73 offset:43296
    ds_write_addtid_b32 v74 offset:44352
    ds_write_addtid_b32 v75 offset:45408
    ds_write_addtid_b32 v76 offset:46464
    ds_write_addtid_b32 v77 offset:47520
    ds_write_addtid_b32 v78 offset:48576
    ds_write_addtid_b32 v79 offset:49632
    ds_write_addtid_b32 v216 offset:50688
    ds_write_addtid_b32 v217 offset:51744
    ds_write_addtid_b32 v218 offset:52800
    ds_write_addtid_b32 v219 offset:53856
    ds_write_addtid_b32 v220 offset:54912
    ds_write_addtid_b32 v221 offset:55968
    ds_write_addtid_b32 v222 offset:57024
    ds_write_addtid_b32 v223 offset:58080
    ds_write_addtid_b32 v224 offset:59136
    ds_write_addtid_b32 v225 offset:60192
    ds_write_addtid_b32 v226 offset:61248
    ds_write_addtid_b32 v227 offset:62304
    ds_write_addtid_b32 v228 offset:63360
    ds_write_addtid_b32 v229 offset:64416
    s_waitcnt lgkmcnt(0)
    s_mov_b64 exec, 1
    ds_add_u32 v3, v5 offset:64384
    s_mov_b64 exec, -1
    s_setprio 1
    s_cmp_lt_u32 s5, 28
    s_cbranch_scc0 L_nl0
    s_barrier
L_nl0:
    s_cmp_lt_u32 s5, 28
    s_cbranch_scc0 L_nl1
    s_barrier
    s_add_u32 s74, s72, 3
    s_and_b32 s74, s74, 7
    s_mul_i32 s75, s74, 229376
    s_add_u32 s75, s75, s71
    s_lshl_b32 s74, s74, 7
    s_add_u32 s74, s74, s70
    s_add_u32 m0, s73, 98304
    s_nop 0
    buffer_load_dwordx4 v16, s[48:51], s74 offen offset:0 lds
    buffer_load_dwordx4 v17, s[48:51], s74 offen offset:1024 lds
    buffer_load_dwordx4 v18, s[48:51], s74 offen offset:2048 lds
    buffer_load_dwordx4 v19, s[48:51], s74 offen offset:3072 lds
    s_add_u32 m0, s73, 114688
    s_nop 0
    buffer_load_dwordx4 v20, s[52:55], s75 offen offset:0 lds
    buffer_load_dwordx4 v21, s[52:55], s75 offen offset:1024 lds
    buffer_load_dwordx4 v22, s[52:55], s75 offen offset:2048 lds
    buffer_load_dwordx4 v23, s[52:55], s75 offen offset:3072 lds
L_nl1:
    s_cmp_lt_u32 s5, 28
    s_cbranch_scc0 L_nl2
    s_barrier
    s_add_u32 s74, s72, 4
    s_and_b32 s74, s74, 7
    s_mul_i32 s75, s74, 229376
    s_add_u32 s75, s75, s71
    s_lshl_b32 s74, s74, 7
    s_add_u32 s74, s74, s70
    s_add_u32 m0, s73, 131072
    s_nop 0
    buffer_load_dwordx4 v16, s[48:51], s74 offen offset:0 lds
    buffer_load_dwordx4 v17, s[48:51], s74 offen offset:1024 lds
    buffer_load_dwordx4 v18, s[48:51], s74 offen offset:2048 lds
    buffer_load_dwordx4 v19, s[48:51], s74 offen offset:3072 lds
    s_add_u32 m0, s73, 147456
    s_nop 0
    buffer_load_dwordx4 v20, s[52:55], s75 offen offset:0 lds
    buffer_load_dwordx4 v21, s[52:55], s75 offen offset:1024 lds
    buffer_load_dwordx4 v22, s[52:55], s75 offen offset:2048 lds
    buffer_load_dwordx4 v23, s[52:55], s75 offen offset:3072 lds
L_nl2:
    s_cmp_lt_u32 s5, 28
    s_cbranch_scc0 L_nl3
    s_waitcnt vmcnt(8)
    s_barrier
    s_add_u32 s74, s72, 5
    s_and_b32 s74, s74, 7
    s_mul_i32 s75, s74, 229376
    s_add_u32 s75, s75, s71
    s_lshl_b32 s74, s74, 7
    s_add_u32 s74, s74, s70
    s_add_u32 m0, s73, 81920
    s_nop 0
    buffer_load_dwordx4 v16, s[48:51], s74 offen offset:0 lds
    buffer_load_dwordx4 v17, s[48:51], s74 offen offset:1024 lds
    buffer_load_dwordx4 v18, s[48:51], s74 offen offset:2048 lds
    buffer_load_dwordx4 v19, s[48:51], s74 offen offset:3072 lds
    s_add_u32 m0, s73, 65536
    s_nop 0
    buffer_load_dwordx4 v20, s[52:55], s75 offen offset:0 lds
    buffer_load_dwordx4 v21, s[52:55], s75 offen offset:1024 lds
    buffer_load_dwordx4 v22, s[52:55], s75 offen offset:2048 lds
    buffer_load_dwordx4 v23, s[52:55], s75 offen offset:3072 lds
L_nl3:
    s_cmp_lt_u32 s5, 28
    s_cbranch_scc0 L_nl4
    s_waitcnt vmcnt(8)
    s_barrier
    s_add_u32 s74, s72, 6
    s_and_b32 s74, s74, 7
    s_mul_i32 s75, s74, 229376
    s_add_u32 s75, s75, s71
    s_lshl_b32 s74, s74, 7
    s_add_u32 s74, s74, s70
    s_add_u32 m0, s73, 98304
    s_nop 0
    buffer_load_dwordx4 v16, s[48:51], s74 offen offset:0 lds
    buffer_load_dwordx4 v17, s[48:51], s74 offen offset:1024 lds
    buffer_load_dwordx4 v18, s[48:51], s74 offen offset:2048 lds
    buffer_load_dwordx4 v19, s[48:51], s74 offen offset:3072 lds
    s_add_u32 m0, s73, 114688
    s_nop 0
    buffer_load_dwordx4 v20, s[52:55], s75 offen offset:0 lds
    buffer_load_dwordx4 v21, s[52:55], s75 offen offset:1024 lds
    buffer_load_dwordx4 v22, s[52:55], s75 offen offset:2048 lds
    buffer_load_dwordx4 v23, s[52:55], s75 offen offset:3072 lds
L_nl4:
    s_cmp_lt_u32 s5, 28
    s_cbranch_scc0 L_nl5
    s_waitcnt vmcnt(8)
    s_barrier
    s_add_u32 s74, s72, 7
    s_and_b32 s74, s74, 7
    s_mul_i32 s75, s74, 229376
    s_add_u32 s75, s75, s71
    s_lshl_b32 s74, s74, 7
    s_add_u32 s74, s74, s70
    s_add_u32 m0, s73, 131072
    s_nop 0
    buffer_load_dwordx4 v16, s[48:51], s74 offen offset:0 lds
    buffer_load_dwordx4 v17, s[48:51], s74 offen offset:1024 lds
    buffer_load_dwordx4 v18, s[48:51], s74 offen offset:2048 lds
    buffer_load_dwordx4 v19, s[48:51], s74 offen offset:3072 lds
    s_add_u32 m0, s73, 147456
    s_nop 0
    buffer_load_dwordx4 v20, s[52:55], s75 offen offset:0 lds
    buffer_load_dwordx4 v21, s[52:55], s75 offen offset:1024 lds
    buffer_load_dwordx4 v22, s[52:55], s75 offen offset:2048 lds
    buffer_load_dwordx4 v23, s[52:55], s75 offen offset:3072 lds
L_nl5:
    s_cmp_lt_u32 s5, 28
    s_cbranch_scc0 L_nl6
    s_waitcnt vmcnt(8)
    s_barrier
L_nl6:
    global_load_dword v2, v3, s[44:45] sc1
    buffer_load_dword v9, v253, s[64:67], 0 offen sc1
    s_cmp_lt_u32 s5, 28
    s_cbranch_scc0 L_nl7
    s_waitcnt vmcnt(2)
    s_barrier
L_nl7:
    s_waitcnt vmcnt(0)
    v_readfirstlane_b32 s7, v2
    s_mov_b32 s3, 0
    s_waitcnt lgkmcnt(0)
L_ep6:
    s_cmp_lg_u32 s7, 0
    s_cbranch_scc1 L_epx6
    s_add_u32 s3, s3, 1
    s_cmp_gt_u32 s3, 40000
    s_cbranch_scc1 L_epx6
    s_sleep 2
    global_load_dword v2, v3, s[44:45] sc1
    s_waitcnt vmcnt(0)
    v_readfirstlane_b32 s7, v2
    s_nop 1
    s_branch L_ep6
L_epx6:
    s_mov_b32 s68, s7
    s_mov_b32 s69, s7
    v_mov_b32 v2, s7
    ds_write_b32 v3, v2 offset:64392
    s_waitcnt vmcnt(0)
    v_cmp_ne_u32 vcc, s7, v9
    s_cbranch_vccz L_c1y
    buffer_load_dword v9, v253, s[64:67], 0 offen sc1
    s_branch L_c1
L_c1y:
    s_mov_b32 s14, 0
    buffer_load_dwordx4 v[176:179], v251, s[64:67], s32 offen sc1
    buffer_load_dwordx4 v[236:239], v251, s[64:67], s33 offen sc1
L_c1:
    s_mov_b32 s3, 0
L_bs7:
    ds_read_b32 v8, v3 offset:64384
    s_add_u32 s3, s3, 1
    s_waitcnt lgkmcnt(0)
    v_readfirstlane_b32 s8, v8
    s_cmp_gt_u32 s3, 3000000
    s_cbranch_scc1 L_bsx7
    s_cmp_lt_u32 s8, 4
    s_cbranch_scc1 L_bs7
L_bsx7:
    s_and_b32 s8, s6, 1
    s_lshl_b32 s8, s8, 6
    v_cmp_eq_u32 vcc, s8, v1
    v_mov_b32 v217, 0
    v_mov_b32 v218, 0
    v_mov_b32 v219, 0
    v_cndmask_b32 v216, 0, v183, vcc
    ds_read_b128 v[32:35], v240 offset:0
    ds_read_b128 v[36:39], v240 offset:64
    ds_read_b128 v[40:43], v240 offset:128
    ds_read_b128 v[44:47], v240 offset:192
    ds_read_b128 v[48:51], v240 offset:256
    ds_read_b128 v[52:55], v240 offset:320
    ds_read_b128 v[56:59], v240 offset:384
    ds_read_b128 v[60:63], v240 offset:448
    ds_read_b128 v[64:67], v241 offset:0
    ds_read_b128 v[68:71], v242 offset:0
    ds_read_b128 v[72:75], v241 offset:64
    ds_read_b128 v[76:79], v242 offset:64
    ds_read_b128 v[184:187], v241 offset:128
    ds_read_b128 v[188:191], v242 offset:128
    ds_read_b128 v[192:195], v241 offset:192
    ds_read_b128 v[196:199], v242 offset:192
    s_waitcnt lgkmcnt(7)
    v_mfma_f32_16x16x32_bf16 v[216:219], v[64:67], v[32:35], v[216:219]
    ds_read_b128 v[200:203], v241 offset:256
    s_waitcnt lgkmcnt(7)
    v_mfma_f32_16x16x32_bf16 v[220:223], v[68:71], v[32:35], 0
    ds_read_b128 v[204:207], v242 offset:256
    s_waitcnt lgkmcnt(7)
    v_mfma_f32_16x16x32_bf16 v[216:219], v[72:75], v[36:39], v[216:219]
    ds_read_b128 v[208:211], v241 offset:320
    s_waitcnt lgkmcnt(7)
    v_mfma_f32_16x16x32_bf16 v[220:223], v[76:79], v[36:39], v[220:223]
    ds_read_b128 v[212:215], v242 offset:320
    s_waitcnt lgkmcnt(7)
    v_mfma_f32_16x16x32_bf16 v[216:219], v[184:187], v[40:43], v[216:219]
    ds_read_b128 v[64:67], v241 offset:384
    s_waitcnt lgkmcnt(7)
    v_mfma_f32_16x16x32_bf16 v[220:223], v[188:191], v[40:43], v[220:223]
    ds_read_b128 v[68:71], v242 offset:384
    s_waitcnt lgkmcnt(7)
    v_mfma_f32_16x16x32_bf16 v[216:219], v[192:195], v[44:47], v[216:219]
    ds_read_b128 v[72:75], v241 offset:448
    s_waitcnt lgkmcnt(7)
    v_mfma_f32_16x16x32_bf16 v[220:223], v[196:199], v[44:47], v[220:223]
    ds_read_b128 v[76:79], v242 offset:448
    s_waitcnt lgkmcnt(7)
    v_mfma_f32_16x16x32_bf16 v[216:219], v[200:203], v[48:51], v[216:219]
    s_waitcnt lgkmcnt(6)
    v_mfma_f32_16x16x32_bf16 v[220:223], v[204:207], v[48:51], v[220:223]
    s_waitcnt lgkmcnt(5)
    v_mfma_f32_16x16x32_bf16 v[216:219], v[208:211], v[52:55], v[216:219]
    s_waitcnt lgkmcnt(4)
    v_mfma_f32_16x16x32_bf16 v[220:223], v[212:215], v[52:55], v[220:223]
    s_waitcnt lgkmcnt(3)
    v_mfma_f32_16x16x32_bf16 v[216:219], v[64:67], v[56:59], v[216:219]
    s_waitcnt lgkmcnt(2)
    v_mfma_f32_16x16x32_bf16 v[220:223], v[68:71], v[56:59], v[220:223]
    s_waitcnt lgkmcnt(1)
    v_mfma_f32_16x16x32_bf16 v[216:219], v[72:75], v[60:63], v[216:219]
    s_waitcnt lgkmcnt(0)
    v_mfma_f32_16x16x32_bf16 v[220:223], v[76:79], v[60:63], v[220:223]
    s_mov_b64 exec, 1
    ds_add_u32 v3, v5 offset:64384
    s_mov_b64 exec, -1
    s_mov_b32 s3, 0
L_bs8:
    ds_read_b32 v8, v3 offset:64384
    s_add_u32 s3, s3, 1
    s_waitcnt lgkmcnt(0)
    v_readfirstlane_b32 s8, v8
    s_cmp_gt_u32 s3, 3000000
    s_cbranch_scc1 L_bsx8
    s_cmp_lt_u32 s8, 8
    s_cbranch_scc1 L_bs8
L_bsx8:
    s_bitcmp1_b32 s6, 0
    s_cbranch_scc1 L_sk1
    ds_bpermute_b32 v224, v243, v216
    ds_bpermute_b32 v225, v243, v217
    ds_bpermute_b32 v226, v243, v218
    ds_bpermute_b32 v227, v243, v220
    ds_bpermute_b32 v228, v243, v221
    v_readfirstlane_b32 s8, v220
    v_readfirstlane_b32 s9, v221
    v_readfirstlane_b32 s10, v222
    s_waitcnt lgkmcnt(0)
    s_nop 0
    v_writelane_b32 v224, s8, 63
    v_writelane_b32 v225, s8, 63
    v_writelane_b32 v226, s9, 63
    v_writelane_b32 v227, s10, 63
    v_writelane_b32 v228, s10, 63
    v_cvt_pk_bf16_f32 v32, v219, v218
    v_cvt_pk_bf16_f32 v33, v217, v216
    ds_write_b64 v244, v[32:33] offset:512
    v_cvt_pk_bf16_f32 v34, v224, v219
    v_cvt_pk_bf16_f32 v35, v218, v217
    ds_write_b64 v244, v[34:35] offset:4672
    v_cvt_pk_bf16_f32 v36, v225, v224
    v_cvt_pk_bf16_f32 v37, v219, v218
    ds_write_b64 v244, v[36:37] offset:8832
    v_cvt_pk_bf16_f32 v38, v226, v225
    v_cvt_pk_bf16_f32 v39, v224, v219
    ds_write_b64 v244, v[38:39] offset:12992
    v_cvt_pk_bf16_f32 v40, v227, v221
    v_cvt_pk_bf16_f32 v41, v220, v220
    ds_write_b64 v244, v[40:41] offset:0
    v_cvt_pk_bf16_f32 v42, v227, v227
    v_cvt_pk_bf16_f32 v43, v221, v220
    ds_write_b64 v244, v[42:43] offset:4160
    v_cvt_pk_bf16_f32 v44, v227, v227
    v_cvt_pk_bf16_f32 v45, v227, v221
    ds_write_b64 v244, v[44:45] offset:8320
    v_cvt_pk_bf16_f32 v46, v228, v227
    v_cvt_pk_bf16_f32 v47, v227, v227
    ds_write_b64 v244, v[46:47] offset:12480
    v_readfirstlane_b32 s8, v33
    v_readfirstlane_b32 s9, v35
    v_mov_b32 v48, 0
    v_mov_b32 v49, 0
    s_lshr_b32 s10, s8, 16
    v_writelane_b32 v48, s10, 8
    v_writelane_b32 v48, s8, 16
    v_writelane_b32 v48, s9, 24
    v_writelane_b32 v49, s10, 24
    s_mov_b32 exec_hi, 0
    ds_write_b64 v252, v[48:49]
    s_mov_b32 exec_hi, -1
    s_branch L_skj
L_sk1:
    v_cvt_pk_bf16_f32 v32, v218, v218
    v_cvt_pk_bf16_f32 v33, v217, v217
    v_cvt_pk_bf16_f32 v34, v217, v216
    v_cvt_pk_bf16_f32 v35, v216, v216
    ds_write_b128 v244, v[32:35] offset:0
    v_cvt_pk_bf16_f32 v36, v222, v222
    v_cvt_pk_bf16_f32 v37, v222, v222
    v_cvt_pk_bf16_f32 v38, v221, v221
    v_cvt_pk_bf16_f32 v39, v221, v221
    ds_write_b128 v245, v[36:39] offset:0
    v_cvt_pk_bf16_f32 v40, v221, v221
    v_cvt_pk_bf16_f32 v41, v221, v220
    v_cvt_pk_bf16_f32 v42, v220, v220
    v_cvt_pk_bf16_f32 v43, v220, v220
    ds_write_b128 v245, v[40:43] offset:16
    v_cvt_pk_bf16_f32 v44, v218, v218
    v_cvt_pk_bf16_f32 v45, v218, v217
    v_cvt_pk_bf16_f32 v46, v217, v217
    v_cvt_pk_bf16_f32 v47, v216, v216
    ds_write_b128 v244, v[44:47] offset:4160
    v_cvt_pk_bf16_f32 v48, v222, v222
    v_cvt_pk_bf16_f32 v49, v222, v222
    v_cvt_pk_bf16_f32 v50, v222, v221
    v_cvt_pk_bf16_f32 v51, v221, v221
    ds_write_b128 v245, v[48:51] offset:4160
    v_cvt_pk_bf16_f32 v52, v221, v221
    v_cvt_pk_bf16_f32 v53, v221, v221
    v_cvt_pk_bf16_f32 v54, v220, v220
    v_cvt_pk_bf16_f32 v55, v220, v220
    ds_write_b128 v245, v[52:55] offset:4176
    v_cvt_pk_bf16_f32 v56, v218, v218
    v_cvt_pk_bf16_f32 v57, v218, v218
    v_cvt_pk_bf16_f32 v58, v217, v217
    v_cvt_pk_bf16_f32 v59, v217, v216
    ds_write_b128 v244, v[56:59] offset:8320
    v_cvt_pk_bf16_f32 v60, v222, v222
    v_cvt_pk_bf16_f32 v61, v222, v222
    v_cvt_pk_bf16_f32 v62, v222, v222
    v_cvt_pk_bf16_f32 v63, v221, v221
    ds_write_b128 v245, v[60:63] offset:8320
    v_cvt_pk_bf16_f32 v64, v221, v221
    v_cvt_pk_bf16_f32 v65, v221, v221
    v_cvt_pk_bf16_f32 v66, v221, v220
    v_cvt_pk_bf16_f32 v67, v220, v220
    ds_write_b128 v245, v[64:67] offset:8336
    v_cvt_pk_bf16_f32 v68, v218, v218
    v_cvt_pk_bf16_f32 v69, v218, v218
    v_cvt_pk_bf16_f32 v70, v218, v217
    v_cvt_pk_bf16_f32 v71, v217, v217
    ds_write_b128 v244, v[68:71] offset:12480
    v_cvt_pk_bf16_f32 v72, v222, v222
    v_cvt_pk_bf16_f32 v73, v222, v222
    v_cvt_pk_bf16_f32 v74, v222, v222
    v_cvt_pk_bf16_f32 v75, v222, v221
    ds_write_b128 v245, v[72:75] offset:12480
    v_cvt_pk_bf16_f32 v76, v221, v221
    v_cvt_pk_bf16_f32 v77, v221, v221
    v_cvt_pk_bf16_f32 v78, v221, v221
    v_cvt_pk_bf16_f32 v79, v220, v220
    ds_write_b128 v245, v[76:79] offset:12496
L_skj:
    s_setprio 3
    s_cmp_eq_u32 s14, 0
    s_cbranch_scc1 L_haveu
    s_waitcnt vmcnt(0)
    v_cmp_ne_u32 vcc, s7, v9
    s_cbranch_vccz L_pollx9
    s_mov_b32 s3, 0
L_poll9:
    buffer_load_dword v9, v253, s[64:67], 0 offen sc1
    s_add_u32 s3, s3, 1
    s_waitcnt vmcnt(0)
    v_cmp_ne_u32 vcc, s7, v9
    s_cmp_gt_u32 s3, 40000
    s_cbranch_scc1 L_pollx9
    s_cbranch_vccz L_pollx9
    s_sleep 2
    s_branch L_poll9
L_pollx9:
    buffer_load_dwordx4 v[176:179], v251, s[64:67], s32 offen sc1
    buffer_load_dwordx4 v[236:239], v251, s[64:67], s33 offen sc1
L_haveu:
    v_mov_b32 v10, 0
    v_mov_b32 v11, 0
    ds_write_b64 v254, v[10:11]
    s_waitcnt vmcnt(0)
    ds_write_b128 v246, v[176:179]
    ds_write_b128 v246, v[236:239] offset:512
    s_waitcnt lgkmcnt(0)
    s_mov_b64 exec, 1
    ds_add_u32 v3, v5 offset:64384
    s_mov_b64 exec, -1
    s_mov_b32 s3, 0
L_bs10:
    ds_read_b32 v8, v3 offset:64384
    s_add_u32 s3, s3, 1
    s_waitcnt lgkmcnt(0)
    v_readfirstlane_b32 s8, v8
    s_cmp_gt_u32 s3, 3000000
    s_cbranch_scc1 L_bsx10
    s_cmp_lt_u32 s8, 12
    s_cbranch_scc1 L_bs10
L_bsx10:
    s_setprio 1
    ds_read_b64 v[32:33], v247 offset:3776
    ds_read_b64 v[34:35], v247 offset:3784
    ds_read_b128 v[64:67], v248 offset:192
    ds_read_b64 v[36:37], v247 offset:3264
    ds_read_b64 v[38:39], v247 offset:3272
    ds_read_b128 v[68:71], v248 offset:704
    ds_read_b64 v[40:41], v247 offset:2752
    ds_read_b64 v[42:43], v247 offset:2760
    ds_read_b128 v[72:75], v248 offset:1216
    ds_read_b64 v[44:45], v247 offset:2240
    ds_read_b64 v[46:47], v247 offset:2248
    ds_read_b128 v[76:79], v248 offset:1728
    ds_read_b64 v[48:49], v247 offset:1728
    ds_read_b64 v[50:51], v247 offset:1736
    ds_read_b128 v[80:83], v248 offset:2240
    ds_read_b64 v[52:53], v247 offset:1216
    ds_read_b64 v[54:55], v247 offset:1224
    ds_read_b128 v[84:87], v248 offset:2752
    ds_read_b64 v[56:57], v247 offset:704
    ds_read_b64 v[58:59], v247 offset:712
    ds_read_b128 v[88:91], v248 offset:3264
    ds_read_b64 v[60:61], v247 offset:192
    ds_read_b64 v[62:63], v247 offset:200
    ds_read_b128 v[92:95], v248 offset:3776
    s_waitcnt lgkmcnt(15)
    v_mfma_f32_16x16x32_bf16 v[160:163], v[32:35], v[64:67], 0
    s_waitcnt lgkmcnt(15)
    v_mfma_f32_16x16x32_bf16 v[164:167], v[32:35], v[68:71], 0
    v_mfma_f32_16x16x32_bf16 v[164:167], v[36:39], v[64:67], v[164:167]
    v_mfma_f32_16x16x32_bf16 v[168:171], v[36:39], v[68:71], 0
    s_waitcnt lgkmcnt(15)
    v_mfma_f32_16x16x32_bf16 v[168:171], v[32:35], v[72:75], v[168:171]
    ds_read_b64 v[96:97], v247 offset:3712
    v_mfma_f32_16x16x32_bf16 v[168:171], v[40:43], v[64:67], v[168:171]
    ds_read_b64 v[98:99], v247 offset:3720
    v_mfma_f32_16x16x32_bf16 v[172:175], v[36:39], v[72:75], 0
    ds_read_b128 v[128:131], v248 offset:128
    v_mfma_f32_16x16x32_bf16 v[172:175], v[40:43], v[68:71], v[172:175]
    ds_read_b64 v[100:101], v247 offset:3200
    v_mfma_f32_16x16x32_bf16 v[176:179], v[40:43], v[72:75], 0
    ds_read_b64 v[102:103], v247 offset:3208
    s_waitcnt lgkmcnt(15)
    v_mfma_f32_16x16x32_bf16 v[172:175], v[32:35], v[76:79], v[172:175]
    ds_read_b128 v[132:135], v248 offset:640
    v_mfma_f32_16x16x32_bf16 v[172:175], v[44:47], v[64:67], v[172:175]
    ds_read_b64 v[104:105], v247 offset:2688
    v_mfma_f32_16x16x32_bf16 v[176:179], v[36:39], v[76:79], v[176:179]
    ds_read_b64 v[106:107], v247 offset:2696
    v_mfma_f32_16x16x32_bf16 v[176:179], v[44:47], v[68:71], v[176:179]
    ds_read_b128 v[136:139], v248 offset:1152
    v_mfma_f32_16x16x32_bf16 v[180:183], v[40:43], v[76:79], 0
    ds_read_b64 v[108:109], v247 offset:2176
    v_mfma_f32_16x16x32_bf16 v[180:183], v[44:47], v[72:75], v[180:183]
    ds_read_b64 v[110:111], v247 offset:2184
    v_mfma_f32_16x16x32_bf16 v[184:187], v[44:47], v[76:79], 0
    ds_read_b128 v[140:143], v248 offset:1664
    s_waitcnt lgkmcnt(15)
    v_mfma_f32_16x16x32_bf16 v[176:179], v[32:35], v[80:83], v[176:179]
    ds_read_b64 v[112:113], v247 offset:1664
    v_mfma_f32_16x16x32_bf16 v[176:179], v[48:51], v[64:67], v[176:179]
    ds_read_b64 v[114:115], v247 offset:1672
    v_mfma_f32_16x16x32_bf16 v[180:183], v[36:39], v[80:83], v[180:183]
    ds_read_b128 v[144:147], v248 offset:2176
    v_mfma_f32_16x16x32_bf16 v[180:183], v[48:51], v[68:71], v[180:183]
    ds_read_b64 v[116:117], v247 offset:1152
    v_mfma_f32_16x16x32_bf16 v[184:187], v[40:43], v[80:83], v[184:187]
    ds_read_b64 v[118:119], v247 offset:1160
    v_mfma_f32_16x16x32_bf16 v[184:187], v[48:51], v[72:75], v[184:187]
    ds_read_b128 v[148:151], v248 offset:2688
    v_mfma_f32_16x16x32_bf16 v[188:191], v[44:47], v[80:83], 0
    ds_read_b64 v[120:121], v247 offset:640
    v_mfma_f32_16x16x32_bf16 v[188:191], v[48:51], v[76:79], v[188:191]
    ds_read_b64 v[122:123], v247 offset:648
    s_waitcnt lgkmcnt(15)
    v_mfma_f32_16x16x32_bf16 v[180:183], v[32:35], v[84:87], v[180:183]
    ds_read_b128 v[152:155], v248 offset:3200
    v_mfma_f32_16x16x32_bf16 v[180:183], v[52:55], v[64:67], v[180:183]
    ds_read_b64 v[124:125], v247 offset:128
    v_mfma_f32_16x16x32_bf16 v[184:187], v[36:39], v[84:87], v[184:187]
    ds_read_b64 v[126:127], v247 offset:136
    v_mfma_f32_16x16x32_bf16 v[184:187], v[52:55], v[68:71], v[184:187]
    ds_read_b128 v[156:159], v248 offset:3712
    v_mfma_f32_16x16x32_bf16 v[188:191], v[40:43], v[84:87], v[188:191]
    v_mfma_f32_16x16x32_bf16 v[188:191], v[52:55], v[72:75], v[188:191]
    s_waitcnt lgkmcnt(15)
    v_mfma_f32_16x16x32_bf16 v[184:187], v[32:35], v[88:91], v[184:187]
    v_mfma_f32_16x16x32_bf16 v[184:187], v[56:59], v[64:67], v[184:187]
    v_mfma_f32_16x16x32_bf16 v[188:191], v[36:39], v[88:91], v[188:191]
    v_mfma_f32_16x16x32_bf16 v[188:191], v[56:59], v[68:71], v[188:191]
    s_waitcnt lgkmcnt(15)
    v_mfma_f32_16x16x32_bf16 v[188:191], v[32:35], v[92:95], v[188:191]
    v_mfma_f32_16x16x32_bf16 v[188:191], v[60:63], v[64:67], v[188:191]
    s_waitcnt lgkmcnt(0)
    v_mfma_f32_16x16x32_bf16 v[160:163], v[96:99], v[128:131], v[160:163]
    v_mfma_f32_16x16x32_bf16 v[164:167], v[96:99], v[132:135], v[164:167]
    v_mfma_f32_16x16x32_bf16 v[164:167], v[100:103], v[128:131], v[164:167]
    v_mfma_f32_16x16x32_bf16 v[168:171], v[100:103], v[132:135], v[168:171]
    v_mfma_f32_16x16x32_bf16 v[168:171], v[96:99], v[136:139], v[168:171]
    ds_read_b64 v[32:33], v247 offset:3648
    v_mfma_f32_16x16x32_bf16 v[168:171], v[104:107], v[128:131], v[168:171]
    ds_read_b64 v[34:35], v247 offset:3656
    v_mfma_f32_16x16x32_bf16 v[172:175], v[100:103], v[136:139], v[172:175]
    ds_read_b128 v[64:67], v248 offset:64
    v_mfma_f32_16x16x32_bf16 v[172:175], v[104:107], v[132:135], v[172:175]
    ds_read_b64 v[36:37], v247 offset:3136
    v_mfma_f32_16x16x32_bf16 v[176:179], v[104:107], v[136:139], v[176:179]
    ds_read_b64 v[38:39], v247 offset:3144
    v_mfma_f32_16x16x32_bf16 v[172:175], v[96:99], v[140:143], v[172:175]
    ds_read_b128 v[68:71], v248 offset:576
    v_mfma_f32_16x16x32_bf16 v[172:175], v[108:111], v[128:131], v[172:175]
    ds_read_b64 v[40:41], v247 offset:2624
    v_mfma_f32_16x16x32_bf16 v[176:179], v[100:103], v[140:143], v[176:179]
    ds_read_b64 v[42:43], v247 offset:2632
    v_mfma_f32_16x16x32_bf16 v[176:179], v[108:111], v[132:135], v[176:179]
    ds_read_b128 v[72:75], v248 offset:1088
    v_mfma_f32_16x16x32_bf16 v[180:183], v[104:107], v[140:143], v[180:183]
    ds_read_b64 v[44:45], v247 offset:2112
    v_mfma_f32_16x16x32_bf16 v[180:183], v[108:111], v[136:139], v[180:183]
    ds_read_b64 v[46:47], v247 offset:2120
    v_mfma_f32_16x16x32_bf16 v[184:187], v[108:111], v[140:143], v[184:187]
    ds_read_b128 v[76:79], v248 offset:1600
    v_mfma_f32_16x16x32_bf16 v[176:179], v[96:99], v[144:147], v[176:179]
    ds_read_b64 v[48:49], v247 offset:1600
    v_mfma_f32_16x16x32_bf16 v[176:179], v[112:115], v[128:131], v[176:179]
    ds_read_b64 v[50:51], v247 offset:1608
    v_mfma_f32_16x16x32_bf16 v[180:183], v[100:103], v[144:147], v[180:183]
    ds_read_b128 v[80:83], v248 offset:2112
    v_mfma_f32_16x16x32_bf16 v[180:183], v[112:115], v[132:135], v[180:183]
    ds_read_b64 v[52:53], v247 offset:1088
    v_mfma_f32_16x16x32_bf16 v[184:187], v[104:107], v[144:147], v[184:187]
    ds_read_b64 v[54:55], v247 offset:1096
    v_mfma_f32_16x16x32_bf16 v[184:187], v[112:115], v[136:139], v[184:187]
    ds_read_b128 v[84:87], v248 offset:2624
    v_mfma_f32_16x16x32_bf16 v[188:191], v[108:111], v[144:147], v[188:191]
    ds_read_b64 v[56:57], v247 offset:576
    v_mfma_f32_16x16x32_bf16 v[188:191], v[112:115], v[140:143], v[188:191]
    ds_read_b64 v[58:59], v247 offset:584
    v_mfma_f32_16x16x32_bf16 v[180:183], v[96:99], v[148:151], v[180:183]
    ds_read_b128 v[88:91], v248 offset:3136
    v_mfma_f32_16x16x32_bf16 v[180:183], v[116:119], v[128:131], v[180:183]
    ds_read_b64 v[60:61], v247 offset:64
    v_mfma_f32_16x16x32_bf16 v[184:187], v[100:103], v[148:151], v[184:187]
    ds_read_b64 v[62:63], v247 offset:72
    v_mfma_f32_16x16x32_bf16 v[184:187], v[116:119], v[132:135], v[184:187]
    ds_read_b128 v[92:95], v248 offset:3648
    v_mfma_f32_16x16x32_bf16 v[188:191], v[104:107], v[148:151], v[188:191]
    v_mfma_f32_16x16x32_bf16 v[188:191], v[116:119], v[136:139], v[188:191]
    v_mfma_f32_16x16x32_bf16 v[184:187], v[96:99], v[152:155], v[184:187]
    v_mfma_f32_16x16x32_bf16 v[184:187], v[120:123], v[128:131], v[184:187]
    v_mfma_f32_16x16x32_bf16 v[188:191], v[100:103], v[152:155], v[188:191]
    v_mfma_f32_16x16x32_bf16 v[188:191], v[120:123], v[132:135], v[188:191]
    v_mfma_f32_16x16x32_bf16 v[188:191], v[96:99], v[156:159], v[188:191]
    v_mfma_f32_16x16x32_bf16 v[188:191], v[124:127], v[128:131], v[188:191]
    s_waitcnt lgkmcnt(0)
    v_mfma_f32_16x16x32_bf16 v[160:163], v[32:35], v[64:67], v[160:163]
    v_mfma_f32_16x16x32_bf16 v[164:167], v[32:35], v[68:71], v[164:167]
    v_mfma_f32_16x16x32_bf16 v[164:167], v[36:39], v[64:67], v[164:167]
    v_mfma_f32_16x16x32_bf16 v[168:171], v[36:39], v[68:71], v[168:171]
    v_mfma_f32_16x16x32_bf16 v[168:171], v[32:35], v[72:75], v[168:171]
    ds_read_b64 v[96:97], v247 offset:3584
    v_mfma_f32_16x16x32_bf16 v[168:171], v[40:43], v[64:67], v[168:171]
    ds_read_b64 v[98:99], v247 offset:3592
    v_mfma_f32_16x16x32_bf16 v[172:175], v[36:39], v[72:75], v[172:175]
    ds_read_b128 v[128:131], v248 offset:0
    v_mfma_f32_16x16x32_bf16 v[172:175], v[40:43], v[68:71], v[172:175]
    ds_read_b64 v[100:101], v247 offset:3072
    v_mfma_f32_16x16x32_bf16 v[176:179], v[40:43], v[72:75], v[176:179]
    ds_read_b64 v[102:103], v247 offset:3080
    v_mfma_f32_16x16x32_bf16 v[172:175], v[32:35], v[76:79], v[172:175]
    ds_read_b128 v[132:135], v248 offset:512
    v_mfma_f32_16x16x32_bf16 v[172:175], v[44:47], v[64:67], v[172:175]
    ds_read_b64 v[104:105], v247 offset:2560
    v_mfma_f32_16x16x32_bf16 v[176:179], v[36:39], v[76:79], v[176:179]
    ds_read_b64 v[106:107], v247 offset:2568
    v_mfma_f32_16x16x32_bf16 v[176:179], v[44:47], v[68:71], v[176:179]
    ds_read_b128 v[136:139], v248 offset:1024
    v_mfma_f32_16x16x32_bf16 v[180:183], v[40:43], v[76:79], v[180:183]
    ds_read_b64 v[108:109], v247 offset:2048
    v_mfma_f32_16x16x32_bf16 v[180:183], v[44:47], v[72:75], v[180:183]
    ds_read_b64 v[110:111], v247 offset:2056
    v_mfma_f32_16x16x32_bf16 v[184:187], v[44:47], v[76:79], v[184:187]
    ds_read_b128 v[140:143], v248 offset:1536
    v_mfma_f32_16x16x32_bf16 v[176:179], v[32:35], v[80:83], v[176:179]
    ds_read_b64 v[112:113], v247 offset:1536
    v_mfma_f32_16x16x32_bf16 v[176:179], v[48:51], v[64:67], v[176:179]
    ds_read_b64 v[114:115], v247 offset:1544
    v_mfma_f32_16x16x32_bf16 v[180:183], v[36:39], v[80:83], v[180:183]
    ds_read_b128 v[144:147], v248 offset:2048
    v_mfma_f32_16x16x32_bf16 v[180:183], v[48:51], v[68:71], v[180:183]
    ds_read_b64 v[116:117], v247 offset:1024
    v_mfma_f32_16x16x32_bf16 v[184:187], v[40:43], v[80:83], v[184:187]
    ds_read_b64 v[118:119], v247 offset:1032
    v_mfma_f32_16x16x32_bf16 v[184:187], v[48:51], v[72:75], v[184:187]
    ds_read_b128 v[148:151], v248 offset:2560
    v_mfma_f32_16x16x32_bf16 v[188:191], v[44:47], v[80:83], v[188:191]
    ds_read_b64 v[120:121], v247 offset:512
    v_mfma_f32_16x16x32_bf16 v[188:191], v[48:51], v[76:79], v[188:191]
    ds_read_b64 v[122:123], v247 offset:520
    v_mfma_f32_16x16x32_bf16 v[180:183], v[32:35], v[84:87], v[180:183]
    ds_read_b128 v[152:155], v248 offset:3072
    v_mfma_f32_16x16x32_bf16 v[180:183], v[52:55], v[64:67], v[180:183]
    ds_read_b64 v[124:125], v247 offset:0
    v_mfma_f32_16x16x32_bf16 v[184:187], v[36:39], v[84:87], v[184:187]
    ds_read_b64 v[126:127], v247 offset:8
    v_mfma_f32_16x16x32_bf16 v[184:187], v[52:55], v[68:71], v[184:187]
    ds_read_b128 v[156:159], v248 offset:3584
    v_mfma_f32_16x16x32_bf16 v[188:191], v[40:43], v[84:87], v[188:191]
    v_mfma_f32_16x16x32_bf16 v[188:191], v[52:55], v[72:75], v[188:191]
    v_mfma_f32_16x16x32_bf16 v[184:187], v[32:35], v[88:91], v[184:187]
    v_mfma_f32_16x16x32_bf16 v[184:187], v[56:59], v[64:67], v[184:187]
    v_mfma_f32_16x16x32_bf16 v[188:191], v[36:39], v[88:91], v[188:191]
    v_mfma_f32_16x16x32_bf16 v[188:191], v[56:59], v[68:71], v[188:191]
    v_mfma_f32_16x16x32_bf16 v[188:191], v[32:35], v[92:95], v[188:191]
    v_mfma_f32_16x16x32_bf16 v[188:191], v[60:63], v[64:67], v[188:191]
    s_waitcnt lgkmcnt(0)
    v_mfma_f32_16x16x32_bf16 v[160:163], v[96:99], v[128:131], v[160:163]
    v_mfma_f32_16x16x32_bf16 v[164:167], v[96:99], v[132:135], v[164:167]
    v_mfma_f32_16x16x32_bf16 v[164:167], v[100:103], v[128:131], v[164:167]
    v_mfma_f32_16x16x32_bf16 v[168:171], v[100:103], v[132:135], v[168:171]
    v_mfma_f32_16x16x32_bf16 v[168:171], v[96:99], v[136:139], v[168:171]
    v_mfma_f32_16x16x32_bf16 v[168:171], v[104:107], v[128:131], v[168:171]
    v_mfma_f32_16x16x32_bf16 v[172:175], v[100:103], v[136:139], v[172:175]
    v_mfma_f32_16x16x32_bf16 v[172:175], v[104:107], v[132:135], v[172:175]
    v_mfma_f32_16x16x32_bf16 v[176:179], v[104:107], v[136:139], v[176:179]
    v_mfma_f32_16x16x32_bf16 v[172:175], v[96:99], v[140:143], v[172:175]
    v_mfma_f32_16x16x32_bf16 v[172:175], v[108:111], v[128:131], v[172:175]
    v_mfma_f32_16x16x32_bf16 v[176:179], v[100:103], v[140:143], v[176:179]
    v_mfma_f32_16x16x32_bf16 v[176:179], v[108:111], v[132:135], v[176:179]
    v_mfma_f32_16x16x32_bf16 v[180:183], v[104:107], v[140:143], v[180:183]
    v_mfma_f32_16x16x32_bf16 v[180:183], v[108:111], v[136:139], v[180:183]
    v_mfma_f32_16x16x32_bf16 v[184:187], v[108:111], v[140:143], v[184:187]
    v_mfma_f32_16x16x32_bf16 v[176:179], v[96:99], v[144:147], v[176:179]
    v_mfma_f32_16x16x32_bf16 v[176:179], v[112:115], v[128:131], v[176:179]
    v_mfma_f32_16x16x32_bf16 v[180:183], v[100:103], v[144:147], v[180:183]
    v_mfma_f32_16x16x32_bf16 v[180:183], v[112:115], v[132:135], v[180:183]
    v_mfma_f32_16x16x32_bf16 v[184:187], v[104:107], v[144:147], v[184:187]
    v_mfma_f32_16x16x32_bf16 v[184:187], v[112:115], v[136:139], v[184:187]
    v_mfma_f32_16x16x32_bf16 v[188:191], v[108:111], v[144:147], v[188:191]
    v_mfma_f32_16x16x32_bf16 v[188:191], v[112:115], v[140:143], v[188:191]
    v_mfma_f32_16x16x32_bf16 v[180:183], v[96:99], v[148:151], v[180:183]
    v_mfma_f32_16x16x32_bf16 v[180:183], v[116:119], v[128:131], v[180:183]
    v_mfma_f32_16x16x32_bf16 v[184:187], v[100:103], v[148:151], v[184:187]
    v_mfma_f32_16x16x32_bf16 v[184:187], v[116:119], v[132:135], v[184:187]
    v_mfma_f32_16x16x32_bf16 v[188:191], v[104:107], v[148:151], v[188:191]
    v_mfma_f32_16x16x32_bf16 v[188:191], v[116:119], v[136:139], v[188:191]
    v_mfma_f32_16x16x32_bf16 v[184:187], v[96:99], v[152:155], v[184:187]
    v_mfma_f32_16x16x32_bf16 v[184:187], v[120:123], v[128:131], v[184:187]
    v_mfma_f32_16x16x32_bf16 v[188:191], v[100:103], v[152:155], v[188:191]
    v_mfma_f32_16x16x32_bf16 v[188:191], v[120:123], v[132:135], v[188:191]
    v_mfma_f32_16x16x32_bf16 v[188:191], v[96:99], v[156:159], v[188:191]
    v_mfma_f32_16x16x32_bf16 v[188:191], v[124:127], v[128:131], v[188:191]
    s_setprio 3
    s_bitcmp1_b32 s6, 0
    s_nop 7
    s_cbranch_scc1 L_hw1
    ds_write_b128 v249, v[176:179] offset:0
    ds_write_b128 v249, v[180:183] offset:1024
    ds_write_b128 v249, v[184:187] offset:2048
    ds_write_b128 v249, v[188:191] offset:3072
    s_branch L_hwj
L_hw1:
    ds_write_b128 v249, v[160:163] offset:0
    ds_write_b128 v249, v[164:167] offset:1024
    ds_write_b128 v249, v[168:171] offset:2048
    ds_write_b128 v249, v[172:175] offset:3072
    s_waitcnt lgkmcnt(0)
    v_mov_b32 v160, v176
    v_mov_b32 v161, v177
    v_mov_b32 v162, v178
    v_mov_b32 v163, v179
    v_mov_b32 v164, v180
    v_mov_b32 v165, v181
    v_mov_b32 v166, v182
    v_mov_b32 v167, v183
    v_mov_b32 v168, v184
    v_mov_b32 v169, v185
    v_mov_b32 v170, v186
    v_mov_b32 v171, v187
    v_mov_b32 v172, v188
    v_mov_b32 v173, v189
    v_mov_b32 v174, v190
    v_mov_b32 v175, v191
L_hwj:
    s_waitcnt lgkmcnt(0)
    s_mov_b64 exec, 1
    ds_add_u32 v3, v5 offset:64384
    s_mov_b64 exec, -1
    s_mov_b32 s3, 0
L_bs11:
    ds_read_b32 v8, v3 offset:64384
    s_add_u32 s3, s3, 1
    s_waitcnt lgkmcnt(0)
    v_readfirstlane_b32 s8, v8
    s_cmp_gt_u32 s3, 3000000
    s_cbranch_scc1 L_bsx11
    s_cmp_lt_u32 s8, 16
    s_cbranch_scc1 L_bs11
L_bsx11:
    ds_read_b128 v[176:179], v250 offset:0
    ds_read_b128 v[180:183], v250 offset:1024
    ds_read_b128 v[184:187], v250 offset:2048
    ds_read_b128 v[188:191], v250 offset:3072
    s_waitcnt lgkmcnt(3)
    v_add_f32 v160, v160, v176
    v_add_f32 v161, v161, v177
    v_add_f32 v162, v162, v178
    v_add_f32 v163, v163, v179
    v_cvt_pk_bf16_f32 v20, v160, v161
    v_cvt_pk_bf16_f32 v21, v162, v163
    s_waitcnt lgkmcnt(2)
    v_add_f32 v164, v164, v180
    v_add_f32 v165, v165, v181
    v_add_f32 v166, v166, v182
    v_add_f32 v167, v167, v183
    v_cvt_pk_bf16_f32 v22, v164, v165
    v_cvt_pk_bf16_f32 v23, v166, v167
    s_nop 0
    v_permlane16_swap_b32 v20, v22
    v_permlane16_swap_b32 v21, v23
    buffer_store_dwordx4 v[20:23], v255, s[64:67], s34 offen sc1
    s_waitcnt lgkmcnt(1)
    v_add_f32 v168, v168, v184
    v_add_f32 v169, v169, v185
    v_add_f32 v170, v170, v186
    v_add_f32 v171, v171, v187
    v_cvt_pk_bf16_f32 v24, v168, v169
    v_cvt_pk_bf16_f32 v25, v170, v171
    s_waitcnt lgkmcnt(0)
    v_add_f32 v172, v172, v188
    v_add_f32 v173, v173, v189
    v_add_f32 v174, v174, v190
    v_add_f32 v175, v175, v191
    v_cvt_pk_bf16_f32 v26, v172, v173
    v_cvt_pk_bf16_f32 v27, v174, v175
    s_nop 0
    v_permlane16_swap_b32 v24, v26
    v_permlane16_swap_b32 v25, v27
    buffer_store_dwordx4 v[24:27], v255, s[64:67], s38 offen sc1
    s_waitcnt vmcnt(0)
    s_atomic_swap s7, s[46:47], s35
    s_waitcnt lgkmcnt(0)
L_tail:
L_end:
    s_endpgm
.section .rodata,"a"
.p2align 6
.amdhsa_kernel gated_mix__ssm_conv_s4__dense_activation_relu__prompt_kernel
  .amdhsa_next_free_vgpr 256
  .amdhsa_next_free_sgpr 102
  .amdhsa_accum_offset 256
  .amdhsa_group_segment_fixed_size 0
  .amdhsa_kernarg_size 128
  .amdhsa_user_sgpr_count 2
  .amdhsa_user_sgpr_kernarg_segment_ptr 1
  .amdhsa_system_sgpr_workgroup_id_x 1
.end_amdhsa_kernel
```
